```python
import torch

def _softmax(x, axis=-1):
    return torch.softmax(x, dim=axis)
def _gelu(x):
    return torch.nn.functional.gelu(x, approximate="tanh")
def _silu(x):
    return torch.nn.functional.silu(x)
def _sigmoid(x):
    return torch.sigmoid(x)
def _layernorm(x, axis=-1, eps=1e-5):
    m = x.mean(dim=axis, keepdim=True)
    v = x.var(dim=axis, keepdim=True, unbiased=False)
    return (x - m) / torch.sqrt(v + eps)
def _scatter_add(tgt, idx, src, axis=0):
    return tgt.clone().index_add_(axis, idx, src)
def _segment_sum(src, seg, n):
    out = torch.zeros((n,) + src.shape[1:], dtype=src.dtype)
    return out.index_add_(0, seg, src)
def _pad(x, pw):
    flat = tuple(v for pair in reversed(pw) for v in pair)
    return torch.nn.functional.pad(x, flat)

kernel_name = 'recurrent_scan__compressed_kv_cla__dense_activation_silu__decode'

def setup_inputs():

    _w = (lambda a: (lambda t: t.to(torch.bfloat16) if t.is_floating_point() else t)(torch.as_tensor(a)))
    def _A_setup():
        B, H, Sq, Sk, D, M = 2, 32, 1, 4096, 128, 640
        Dc = 4 * D
        return {
            "x": _w((lambda *s: torch.randn(*s, dtype=torch.bfloat16) * 0.1)(B, Sq, M)),
            "c_kv": _w((lambda *s: torch.randn(*s, dtype=torch.bfloat16) * 3.2)(B, Sk, Dc)),
            "w_q": _w((lambda *s: torch.randn(*s, dtype=torch.bfloat16) * 0.8)(M, H, D) * (M ** -0.5)),
            "w_uk": _w((lambda *s: torch.randn(*s, dtype=torch.bfloat16) * 0.8)(Dc, H, D) * (Dc ** -0.5)),
            "w_uv": _w((lambda *s: torch.randn(*s, dtype=torch.bfloat16) * 3.2)(Dc, H, D) * (Dc ** -0.5)),
            "w_o": _w((lambda *s: torch.randn(*s, dtype=torch.bfloat16) * 3.2)(H, D, M) * ((H * D) ** -0.5)),
        }
    _A_in = _A_setup()

    def _B_setup():
        B, S, D, F = 2, 1, 640, 1728
        return {
            "x": _w((lambda *s: torch.randn(*s, dtype=torch.bfloat16) * 0.1)(B, S, D)),
            "w1": _w((lambda *s: torch.randn(*s, dtype=torch.bfloat16) * 3.2)(D, F) * (D ** -0.5)),
            "w2": _w((lambda *s: torch.randn(*s, dtype=torch.bfloat16) * 3.2)(F, D) * (F ** -0.5)),
        }
    _B_in = _B_setup()

    return {
        "A_x": _A_in["x"],
        "A_c_kv": _A_in["c_kv"],
        "A_w_q": _A_in["w_q"],
        "A_w_uk": _A_in["w_uk"],
        "A_w_uv": _A_in["w_uv"],
        "A_w_o": _A_in["w_o"],
        "B_x": _B_in["x"],
        "B_w1": _B_in["w1"],
        "B_w2": _B_in["w2"],
    }

def reference(A_x, A_c_kv, A_w_q, A_w_uk, A_w_uv, A_w_o, B_x, B_w1, B_w2):
    def _A_ref(x, c_kv, w_q, w_uk, w_uv, w_o):
        B, Sq, M = x.shape[0], x.shape[1], x.shape[2]
        Sk = c_kv.shape[1]
        H, D = w_q.shape[1], w_q.shape[2]
        q = torch.einsum("bqm,mhd->bhqd", x, w_q)
        k = torch.einsum("bkc,chd->bhkd", c_kv, w_uk)
        v = torch.einsum("bkc,chd->bhkd", c_kv, w_uv)
        scores = torch.einsum("bhqd,bhkd->bhqk", q, k) * (D ** -0.5)
        off = Sk - Sq
        qi = torch.arange(Sq)[:, None]
        kj = torch.arange(Sk)[None, :]
        cmask = kj <= (qi + off)
        scores = torch.where(cmask[None, None], scores, -1e9)
        p = _softmax(scores, axis=-1)
        ctx = torch.einsum("bhqk,bhkd->bhqd", p, v)
        return torch.einsum("bhqd,hdm->bqm", ctx, w_o)

    def _B_ref(x, w1, w2):
        h = torch.einsum("bsd,df->bsf", x, w1)
        h = _silu(h)
        out = torch.einsum("bsf,fd->bsd", h, w2)
        return out

    x = A_x
    xn = _layernorm(x, axis=-1)
    s = _A_ref(xn, A_c_kv, A_w_q, A_w_uk, A_w_uv, A_w_o)
    g = _silu(_B_ref(xn, B_w1, B_w2))
    return x + s * g
```

```asm
; @launch grid=(256,1,1) block=(256,1,1) lds=163840
.amdgcn_target "amdgcn-amd-amdhsa--gfx950"
.text
.globl recurrent_scan__compressed_kv_cla__dense_activation_silu__decode_kernel
.p2align 8
.type recurrent_scan__compressed_kv_cla__dense_activation_silu__decode_kernel,@function
recurrent_scan__compressed_kv_cla__dense_activation_silu__decode_kernel:
    s_cmp_ge_u32 s2, 256
    s_cbranch_scc1 L_exit
    s_load_dwordx16 s[4:19], s[0:1], 0
    s_load_dwordx8 s[20:27], s[0:1], 64
    v_lshrrev_b32 v4, 6, v0
    v_and_b32 v1, 63, v0
    v_readfirstlane_b32 s56, v4
    s_getpc_b64 s[62:63]
L_pc:
    s_lshr_b32 s61, s2, 3
    s_lshl_b32 s61, s61, 2
    s_add_u32 s61, s61, s56
    s_cmp_lt_u32 s61, (L_exit-L_pc+1023)/1024
    s_cbranch_scc0 L_nopf
    s_lshl_b32 s61, s61, 10
    s_min_u32 s61, s61, L_exit-L_pc-1024
    v_lshl_add_u32 v5, v1, 4, s61
    global_load_dwordx4 v[248:251], v5, s[62:63]
L_nopf:
    v_and_b32 v2, 15, v0
    v_bfe_u32 v3, v0, 4, 2
    s_and_b32 s57, s2, 31
    s_lshr_b32 s58, s2, 5
    v_mov_b32 v244, -1
    v_mov_b32 v245, -1
    v_mov_b32 v246, -1
    v_mov_b32 v247, -1
    s_waitcnt lgkmcnt(0)
    s_mov_b32 s28, s4
    s_and_b32 s29, s5, 0xffff
    s_mov_b32 s30, 2560
    s_mov_b32 s31, 0x00020000
    s_mov_b32 s36, s26
    s_and_b32 s37, s27, 0xffff
    s_mov_b32 s38, 3670016
    s_mov_b32 s39, 0x00020000
    s_mov_b32 s32, s8
    s_and_b32 s33, s9, 0xffff
    s_mov_b32 s34, 5242880
    s_mov_b32 s35, 0x00020000
    s_cmp_eq_u32 s56, 0
    s_cbranch_scc0 L_w123
    v_lshrrev_b32 v4, 5, v1
    v_and_b32 v5, 31, v1
    v_mul_u32_u24 v4, 1280, v4
    v_mul_u32_u24 v5, 40, v5
    v_add_u32 v4, v4, v5
    v_mov_b32 v6, 0
    buffer_load_dwordx4 v[10:13], v4, s[28:31], 0 offen
    buffer_load_dwordx4 v[14:17], v4, s[28:31], 0 offen offset:16
    buffer_load_dwordx2 v[18:19], v4, s[28:31], 0 offen offset:32
    buffer_load_dword v202, v6, s[36:39], 0 offen offset:0 sc1
    s_mul_i32 s61, s58, 655360
    s_lshl_b32 s62, s57, 8
    s_add_u32 s61, s61, s62
    v_mul_u32_u24 v7, 163840, v3
    v_lshl_add_u32 v7, v2, 4, v7
    v_add_u32 v7, s61, v7
    s_mov_b32 s70, 0
    s_movk_i32 s61, 0x2000
    buffer_load_dwordx4 v[20:23], v7, s[32:35], s70 offen
    s_add_u32 s70, s70, s61
    buffer_load_dwordx4 v[24:27], v7, s[32:35], s70 offen
    s_add_u32 s70, s70, s61
    buffer_load_dwordx4 v[28:31], v7, s[32:35], s70 offen
    s_add_u32 s70, s70, s61
    buffer_load_dwordx4 v[32:35], v7, s[32:35], s70 offen
    s_add_u32 s70, s70, s61
    buffer_load_dwordx4 v[36:39], v7, s[32:35], s70 offen
    s_add_u32 s70, s70, s61
    buffer_load_dwordx4 v[40:43], v7, s[32:35], s70 offen
    s_add_u32 s70, s70, s61
    buffer_load_dwordx4 v[44:47], v7, s[32:35], s70 offen
    s_add_u32 s70, s70, s61
    buffer_load_dwordx4 v[48:51], v7, s[32:35], s70 offen
    s_add_u32 s70, s70, s61
    buffer_load_dwordx4 v[52:55], v7, s[32:35], s70 offen
    s_add_u32 s70, s70, s61
    buffer_load_dwordx4 v[56:59], v7, s[32:35], s70 offen
    s_add_u32 s70, s70, s61
    buffer_load_dwordx4 v[60:63], v7, s[32:35], s70 offen
    s_add_u32 s70, s70, s61
    buffer_load_dwordx4 v[64:67], v7, s[32:35], s70 offen
    s_add_u32 s70, s70, s61
    buffer_load_dwordx4 v[68:71], v7, s[32:35], s70 offen
    s_add_u32 s70, s70, s61
    buffer_load_dwordx4 v[72:75], v7, s[32:35], s70 offen
    s_add_u32 s70, s70, s61
    buffer_load_dwordx4 v[76:79], v7, s[32:35], s70 offen
    s_add_u32 s70, s70, s61
    buffer_load_dwordx4 v[80:83], v7, s[32:35], s70 offen
    s_add_u32 s70, s70, s61
    buffer_load_dwordx4 v[84:87], v7, s[32:35], s70 offen
    s_add_u32 s70, s70, s61
    buffer_load_dwordx4 v[88:91], v7, s[32:35], s70 offen
    s_add_u32 s70, s70, s61
    buffer_load_dwordx4 v[92:95], v7, s[32:35], s70 offen
    s_add_u32 s70, s70, s61
    buffer_load_dwordx4 v[96:99], v7, s[32:35], s70 offen
    s_barrier
    s_branch L_w0
L_w123:
    v_mov_b32 v4, 0
    buffer_load_dword v202, v4, s[36:39], 0 offen offset:0 sc1
    s_cmp_eq_u32 s56, 2
    s_cbranch_scc0 L_tlb_1
    v_lshlrev_b32 v5, 20, v1
    s_mov_b32 s44, s6
    s_and_b32 s45, s7, 0xffff
    s_mov_b32 s46, 8388608
    s_mov_b32 s47, 0x00020000
    buffer_load_dword v252, v5, s[44:47], 0 offen
    s_mov_b32 s44, s12
    s_and_b32 s45, s13, 0xffff
    s_mov_b32 s46, 4194304
    s_mov_b32 s47, 0x00020000
    buffer_load_dword v252, v5, s[44:47], 0 offen
    s_mov_b32 s44, s14
    s_and_b32 s45, s15, 0xffff
    s_mov_b32 s46, 5242880
    s_mov_b32 s47, 0x00020000
    buffer_load_dword v252, v5, s[44:47], 0 offen
    s_mov_b32 s44, s18
    s_and_b32 s45, s19, 0xffff
    s_mov_b32 s46, 2211840
    s_mov_b32 s47, 0x00020000
    buffer_load_dword v252, v5, s[44:47], 0 offen
    s_mov_b32 s44, s20
    s_and_b32 s45, s21, 0xffff
    s_mov_b32 s46, 2211840
    s_mov_b32 s47, 0x00020000
    buffer_load_dword v252, v5, s[44:47], 0 offen
L_tlb_1:
    s_cmp_ge_u32 s58, 4
    s_cbranch_scc1 L_Bw123
    v_mov_b32 v206, 0
    v_mov_b32 v192, 0
    v_mov_b32 v193, 0
    v_mov_b32 v194, 0
    v_mov_b32 v195, 0
    s_mov_b32 s69, 0x7f000000
    s_mov_b32 s40, s10
    s_and_b32 s41, s11, 0xffff
    s_mov_b32 s42, 4194304
    s_mov_b32 s43, 0x00020000
    s_cmp_eq_u32 s56, 3
    s_cbranch_scc0 L_pcl_2
    v_lshlrev_b32 v8, 4, v1
    s_mul_i32 s62, s57, 5120
    s_mul_i32 s63, s58, 1280
    s_add_u32 s62, s62, s63
    s_add_u32 s62, s62, 413696
    buffer_store_dwordx4 v[244:247], v8, s[36:39], s62 offen sc1
    v_lshlrev_b32 v9, 4, v2
    buffer_store_dwordx4 v[244:247], v9, s[36:39], s62 offen offset:1024 sc1
    v_and_b32 v8, 1, v3
    v_lshlrev_b32 v8, 15, v8
    v_lshl_add_u32 v8, v2, 4, v8
    s_lshl_b32 s62, s57, 10
    s_lshl_b32 s63, s58, 8
    s_add_u32 s62, s62, s63
    s_add_u32 s62, s62, 266240
    buffer_store_dwordx4 v[244:247], v8, s[36:39], s62 offen sc1
    s_lshl_b32 s61, s57, 2
    s_add_u32 s61, s61, s58
    v_and_b32 v8, 31, v1
    v_lshlrev_b32 v8, 4, v8
    s_lshl_b32 s62, s61, 9
    s_add_u32 s62, s62, 348160
    buffer_store_dwordx4 v[244:247], v8, s[36:39], s62 offen sc1
    s_add_u32 s62, s62, 602112
    buffer_store_dwordx4 v[244:247], v8, s[36:39], s62 offen sc1
    s_lshl_b32 s62, s57, 9
    s_add_u32 s62, s62, 331776
    buffer_store_dwordx4 v[244:247], v8, s[36:39], s62 offen sc1
L_pcl_2:
    s_barrier
    s_sub_u32 s63, s56, 1
    s_mul_i32 s63, s63, 11
    s_mul_i32 s61, s58, 1048576
    s_lshl_b32 s62, s57, 8
    s_add_u32 s61, s61, s62
    s_lshl_b32 s62, s63, 15
    s_add_u32 s61, s61, s62
    s_lshl_b32 s62, s63, 10
    s_add_u32 s62, s62, 32768
    v_lshlrev_b32 v9, 13, v3
    s_add_u32 s65, s63, 11
L_wuk_3:
    s_and_b32 s64, s63, 3
    s_lshl_b32 s64, s64, 2
    v_add_u32 v8, s64, v3
    v_xor_b32 v8, v8, v2
    v_lshl_add_u32 v8, v8, 4, v9
    s_mov_b32 m0, s62
    s_add_u32 s62, s62, 1024
    buffer_load_dwordx4 v8, s[40:43], s61 offen lds
    s_add_u32 s61, s61, 32768
    s_add_u32 s63, s63, 1
    s_cmp_lt_u32 s63, s65
    s_cbranch_scc1 L_wuk_3
    s_waitcnt vmcnt(11)
    v_readfirstlane_b32 s59, v202
    s_nop 3
    s_add_u32 s59, s59, 1
    s_mul_i32 s60, s59, 0x9e3779b1
    s_xor_b32 s60, s60, 0x5bd1e995
    s_cmp_eq_u32 s56, 3
    s_cbranch_scc0 L_pcf_4
    s_lshl_b32 s64, s57, 2
    s_add_u32 s64, s64, s58
    s_lshl_b32 s64, s64, 3
    s_add_u32 s64, s64, 925696
    v_mov_b32 v190, s59
    v_mov_b32 v191, s60
    v_mov_b32 v192, 0
    s_mov_b64 exec, 1
    buffer_store_dwordx2 v[190:191], v192, s[36:39], s64 offen sc1
    s_mov_b64 exec, -1
L_pcf_4:
    s_branch L_P_join
L_Bw123:
    s_sub_u32 s10, s58, 4
    s_and_b32 s67, s10, 1
    s_lshr_b32 s66, s10, 1
    s_lshl_b32 s68, s10, 5
    s_add_u32 s68, s68, s57
    s_and_b32 s11, s68, 63
    s_lshr_b32 s61, s68, 6
    s_add_u32 s13, s61, 1
    s_cmp_lt_u32 s11, 54
    s_cselect_b32 s13, s13, 3
    s_mul_i32 s61, s61, 10
    s_add_u32 s12, s11, s61
    s_sub_u32 s12, s12, 54
    s_mov_b32 s40, s6
    s_and_b32 s41, s7, 0xffff
    s_mov_b32 s42, 8388608
    s_mov_b32 s43, 0x00020000
    s_lshl_b32 s24, s66, 12
    s_lshl_b32 s62, s57, 7
    s_add_u32 s24, s24, s62
    s_lshl_b32 s62, s56, 5
    s_add_u32 s24, s24, s62
    s_lshl_b32 s24, s24, 10
    s_mul_i32 s25, s56, 33792
    s_add_u32 s25, s25, 0
    v_lshlrev_b32 v240, 4, v1
    s_mul_i32 s64, s67, 16384
    s_add_u32 s24, s24, s64
    s_mul_i32 s64, s67, 16896
    s_add_u32 s25, s25, s64
    s_barrier
    v_lshlrev_b32 v8, 4, v1
    s_lshl_b32 s61, s57, 2
    s_add_u32 s61, s61, s10
    s_lshl_b32 s61, s61, 14
    s_add_u32 s61, s61, 1048576
    s_mul_i32 s62, s56, 5120
    s_add_u32 s61, s61, s62
    s_sub_u32 s61, s61, 4096
    buffer_store_dwordx4 v[244:247], v8, s[36:39], s61 offen offset:0 sc1
    buffer_store_dwordx4 v[244:247], v8, s[36:39], s61 offen offset:1024 sc1
    buffer_store_dwordx4 v[244:247], v8, s[36:39], s61 offen offset:2048 sc1
    buffer_store_dwordx4 v[244:247], v8, s[36:39], s61 offen offset:3072 sc1
    s_add_u32 s61, s61, 4096
    buffer_store_dwordx4 v[244:247], v8, s[36:39], s61 offen offset:0 sc1
    s_cmp_eq_u32 s56, 1
    s_cbranch_scc0 L_cb_5_2
    s_sub_u32 s61, s61, 5120
    buffer_store_dwordx4 v[244:247], v8, s[36:39], s61 offen sc1
    s_branch L_cb_5
L_cb_5_2:
    s_cmp_eq_u32 s56, 2
    s_cbranch_scc0 L_cb_5
    s_cmp_eq_u32 s13, 2
    s_cbranch_scc0 L_cb_5
    s_mul_i32 s61, s11, 5120
    s_add_u32 s61, s61, 577536
    buffer_store_dwordx4 v[244:247], v8, s[36:39], s61 offen offset:0 sc1
    buffer_store_dwordx4 v[244:247], v8, s[36:39], s61 offen offset:1024 sc1
    buffer_store_dwordx4 v[244:247], v8, s[36:39], s61 offen offset:2048 sc1
    buffer_store_dwordx4 v[244:247], v8, s[36:39], s61 offen offset:3072 sc1
    s_add_u32 s61, s61, 4096
    buffer_store_dwordx4 v[244:247], v8, s[36:39], s61 offen offset:0 sc1
L_cb_5:
    s_barrier
    s_branch L_B_rows0
L_w0:
    v_and_b32 v204, 1, v1
    v_bfe_u32 v205, v1, 1, 2
    v_cmp_eq_u32 vcc, 1, v204
    v_mov_b32 v206, 0x0c0c0504
    v_mov_b32 v207, 0x05040c0c
    v_cndmask_b32 v208, v206, v207, vcc
    v_mov_b32 v206, 0x0c0c0706
    v_mov_b32 v207, 0x07060c0c
    v_cndmask_b32 v209, v206, v207, vcc
    v_mov_b32 v206, 0x0c0c0c0c
    v_cmp_eq_u32 vcc, 0, v205
    s_nop 1
    v_cndmask_b32 v180, v206, v208, vcc
    v_cndmask_b32 v181, v206, v209, vcc
    v_cmp_eq_u32 vcc, 1, v205
    s_nop 1
    v_cndmask_b32 v182, v206, v208, vcc
    v_cndmask_b32 v183, v206, v209, vcc
    v_cmp_eq_u32 vcc, 2, v205
    s_nop 1
    v_cndmask_b32 v184, v206, v208, vcc
    v_cndmask_b32 v185, v206, v209, vcc
    v_cmp_eq_u32 vcc, 3, v205
    s_nop 1
    v_cndmask_b32 v186, v206, v208, vcc
    v_cndmask_b32 v187, v206, v209, vcc
    s_mov_b32 s61, 0x3f803f80
    v_mov_b32 v204, 0
    v_mov_b32 v205, 0
    v_mov_b32 v206, 0
    v_mov_b32 v207, 0
    s_waitcnt vmcnt(21)
    v_dot2_f32_bf16 v204, v10, s61, v204
    v_dot2_f32_bf16 v206, v10, v10, v206
    v_dot2_f32_bf16 v205, v11, s61, v205
    v_dot2_f32_bf16 v207, v11, v11, v207
    v_dot2_f32_bf16 v204, v12, s61, v204
    v_dot2_f32_bf16 v206, v12, v12, v206
    v_dot2_f32_bf16 v205, v13, s61, v205
    v_dot2_f32_bf16 v207, v13, v13, v207
    v_dot2_f32_bf16 v204, v14, s61, v204
    v_dot2_f32_bf16 v206, v14, v14, v206
    v_dot2_f32_bf16 v205, v15, s61, v205
    v_dot2_f32_bf16 v207, v15, v15, v207
    v_dot2_f32_bf16 v204, v16, s61, v204
    v_dot2_f32_bf16 v206, v16, v16, v206
    v_dot2_f32_bf16 v205, v17, s61, v205
    v_dot2_f32_bf16 v207, v17, v17, v207
    v_dot2_f32_bf16 v204, v18, s61, v204
    v_dot2_f32_bf16 v206, v18, v18, v206
    v_dot2_f32_bf16 v205, v19, s61, v205
    v_dot2_f32_bf16 v207, v19, v19, v207
    s_nop 2
    v_add_f32 v204, v204, v205
    v_add_f32 v206, v206, v207
    s_nop 0
    v_add_f32_dpp v204, v204, v204 row_ror:8 row_mask:0xf bank_mask:0xf
    v_add_f32_dpp v206, v206, v206 row_ror:8 row_mask:0xf bank_mask:0xf
    s_nop 0
    v_add_f32_dpp v204, v204, v204 row_ror:4 row_mask:0xf bank_mask:0xf
    v_add_f32_dpp v206, v206, v206 row_ror:4 row_mask:0xf bank_mask:0xf
    s_nop 0
    v_add_f32_dpp v204, v204, v204 row_ror:2 row_mask:0xf bank_mask:0xf
    v_add_f32_dpp v206, v206, v206 row_ror:2 row_mask:0xf bank_mask:0xf
    s_nop 0
    v_add_f32_dpp v204, v204, v204 row_ror:1 row_mask:0xf bank_mask:0xf
    v_add_f32_dpp v206, v206, v206 row_ror:1 row_mask:0xf bank_mask:0xf
    s_nop 0
    s_nop 0
    v_permlane16_swap_b32 v204, v206
    s_nop 0
    v_add_f32 v204, v204, v206
    s_nop 0
    v_mov_b32 v206, v204
    s_nop 1
    v_permlane16_swap_b32 v204, v206
    s_nop 0
    v_mul_f32 v204, 0x3acccccd, v204
    v_mul_f32 v206, 0x3acccccd, v206
    v_fma_f32 v206, -v204, v204, v206
    v_max_f32 v206, 0, v206
    v_cvt_pk_bf16_f32 v205, v204, v206
    v_lshlrev_b32 v204, 16, v205
    v_and_b32 v206, 0xffff0000, v205
    v_add_f32 v206, 0x3727c5ac, v206
    v_cvt_pk_bf16_f32 v206, v206, v206
    v_and_b32 v206, 0xffff0000, v206
    v_sqrt_f32 v206, v206
    s_nop 0
    v_cvt_pk_bf16_f32 v206, v206, v206
    v_and_b32 v206, 0xffff0000, v206
    v_rcp_f32 v206, v206
    s_nop 0
    v_mul_f32 v204, v204, v206
    v_sub_f32 v204, 0, v204
    v_lshlrev_b32 v207, 16, v10
    v_and_b32 v208, 0xffff0000, v10
    v_fma_f32 v207, v207, v206, v204
    v_fma_f32 v208, v208, v206, v204
    v_cvt_pk_bf16_f32 v10, v207, v208
    v_lshlrev_b32 v207, 16, v11
    v_and_b32 v208, 0xffff0000, v11
    v_fma_f32 v207, v207, v206, v204
    v_fma_f32 v208, v208, v206, v204
    v_cvt_pk_bf16_f32 v11, v207, v208
    v_lshlrev_b32 v207, 16, v12
    v_and_b32 v208, 0xffff0000, v12
    v_fma_f32 v207, v207, v206, v204
    v_fma_f32 v208, v208, v206, v204
    v_cvt_pk_bf16_f32 v12, v207, v208
    v_lshlrev_b32 v207, 16, v13
    v_and_b32 v208, 0xffff0000, v13
    v_fma_f32 v207, v207, v206, v204
    v_fma_f32 v208, v208, v206, v204
    v_cvt_pk_bf16_f32 v13, v207, v208
    v_lshlrev_b32 v207, 16, v14
    v_and_b32 v208, 0xffff0000, v14
    v_fma_f32 v207, v207, v206, v204
    v_fma_f32 v208, v208, v206, v204
    v_cvt_pk_bf16_f32 v14, v207, v208
    v_lshlrev_b32 v207, 16, v15
    v_and_b32 v208, 0xffff0000, v15
    v_fma_f32 v207, v207, v206, v204
    v_fma_f32 v208, v208, v206, v204
    v_cvt_pk_bf16_f32 v15, v207, v208
    v_lshlrev_b32 v207, 16, v16
    v_and_b32 v208, 0xffff0000, v16
    v_fma_f32 v207, v207, v206, v204
    v_fma_f32 v208, v208, v206, v204
    v_cvt_pk_bf16_f32 v16, v207, v208
    v_lshlrev_b32 v207, 16, v17
    v_and_b32 v208, 0xffff0000, v17
    v_fma_f32 v207, v207, v206, v204
    v_fma_f32 v208, v208, v206, v204
    v_cvt_pk_bf16_f32 v17, v207, v208
    v_lshlrev_b32 v207, 16, v18
    v_and_b32 v208, 0xffff0000, v18
    v_fma_f32 v207, v207, v206, v204
    v_fma_f32 v208, v208, v206, v204
    v_cvt_pk_bf16_f32 v18, v207, v208
    v_lshlrev_b32 v207, 16, v19
    v_and_b32 v208, 0xffff0000, v19
    v_fma_f32 v207, v207, v206, v204
    v_fma_f32 v208, v208, v206, v204
    v_cvt_pk_bf16_f32 v19, v207, v208
    v_add_u32 v207, 152064, v4
    ds_write_b64 v207, v[10:11] offset:0
    ds_write_b64 v207, v[12:13] offset:8
    ds_write_b64 v207, v[14:15] offset:16
    ds_write_b64 v207, v[16:17] offset:24
    ds_write_b64 v207, v[18:19] offset:32
    v_bfe_u32 v204, v1, 3, 1
    v_mul_u32_u24 v204, 1280, v204
    v_mul_u32_u24 v205, 40, v3
    s_mul_i32 s61, s58, 160
    s_add_u32 s61, s61, 152064
    v_add3_u32 v204, v204, v205, s61
    s_waitcnt lgkmcnt(0)
    ds_read_b64 v[192:193], v204 offset:0
    ds_read_b64 v[194:195], v204 offset:8
    ds_read_b64 v[196:197], v204 offset:16
    ds_read_b64 v[198:199], v204 offset:24
    ds_read_b64 v[200:201], v204 offset:32
    s_waitcnt lgkmcnt(0)
    v_perm_b32 v100, v192, v192, v180
    v_perm_b32 v101, v192, v192, v182
    v_perm_b32 v102, v192, v192, v184
    v_perm_b32 v103, v192, v192, v186
    v_perm_b32 v104, v192, v192, v181
    v_perm_b32 v105, v192, v192, v183
    v_perm_b32 v106, v192, v192, v185
    v_perm_b32 v107, v192, v192, v187
    v_perm_b32 v108, v193, v193, v180
    v_perm_b32 v109, v193, v193, v182
    v_perm_b32 v110, v193, v193, v184
    v_perm_b32 v111, v193, v193, v186
    v_perm_b32 v112, v193, v193, v181
    v_perm_b32 v113, v193, v193, v183
    v_perm_b32 v114, v193, v193, v185
    v_perm_b32 v115, v193, v193, v187
    v_perm_b32 v116, v194, v194, v180
    v_perm_b32 v117, v194, v194, v182
    v_perm_b32 v118, v194, v194, v184
    v_perm_b32 v119, v194, v194, v186
    v_perm_b32 v120, v194, v194, v181
    v_perm_b32 v121, v194, v194, v183
    v_perm_b32 v122, v194, v194, v185
    v_perm_b32 v123, v194, v194, v187
    v_perm_b32 v124, v195, v195, v180
    v_perm_b32 v125, v195, v195, v182
    v_perm_b32 v126, v195, v195, v184
    v_perm_b32 v127, v195, v195, v186
    v_perm_b32 v128, v195, v195, v181
    v_perm_b32 v129, v195, v195, v183
    v_perm_b32 v130, v195, v195, v185
    v_perm_b32 v131, v195, v195, v187
    v_perm_b32 v132, v196, v196, v180
    v_perm_b32 v133, v196, v196, v182
    v_perm_b32 v134, v196, v196, v184
    v_perm_b32 v135, v196, v196, v186
    v_perm_b32 v136, v196, v196, v181
    v_perm_b32 v137, v196, v196, v183
    v_perm_b32 v138, v196, v196, v185
    v_perm_b32 v139, v196, v196, v187
    v_perm_b32 v140, v197, v197, v180
    v_perm_b32 v141, v197, v197, v182
    v_perm_b32 v142, v197, v197, v184
    v_perm_b32 v143, v197, v197, v186
    v_perm_b32 v144, v197, v197, v181
    v_perm_b32 v145, v197, v197, v183
    v_perm_b32 v146, v197, v197, v185
    v_perm_b32 v147, v197, v197, v187
    v_perm_b32 v148, v198, v198, v180
    v_perm_b32 v149, v198, v198, v182
    v_perm_b32 v150, v198, v198, v184
    v_perm_b32 v151, v198, v198, v186
    v_perm_b32 v152, v198, v198, v181
    v_perm_b32 v153, v198, v198, v183
    v_perm_b32 v154, v198, v198, v185
    v_perm_b32 v155, v198, v198, v187
    v_perm_b32 v156, v199, v199, v180
    v_perm_b32 v157, v199, v199, v182
    v_perm_b32 v158, v199, v199, v184
    v_perm_b32 v159, v199, v199, v186
    v_perm_b32 v160, v199, v199, v181
    v_perm_b32 v161, v199, v199, v183
    v_perm_b32 v162, v199, v199, v185
    v_perm_b32 v163, v199, v199, v187
    v_perm_b32 v164, v200, v200, v180
    v_perm_b32 v165, v200, v200, v182
    v_perm_b32 v166, v200, v200, v184
    v_perm_b32 v167, v200, v200, v186
    v_perm_b32 v168, v200, v200, v181
    v_perm_b32 v169, v200, v200, v183
    v_perm_b32 v170, v200, v200, v185
    v_perm_b32 v171, v200, v200, v187
    v_perm_b32 v172, v201, v201, v180
    v_perm_b32 v173, v201, v201, v182
    v_perm_b32 v174, v201, v201, v184
    v_perm_b32 v175, v201, v201, v186
    v_perm_b32 v176, v201, v201, v181
    v_perm_b32 v177, v201, v201, v183
    v_perm_b32 v178, v201, v201, v185
    v_perm_b32 v179, v201, v201, v187
    s_waitcnt vmcnt(20)
    v_readfirstlane_b32 s59, v202
    s_nop 3
    s_add_u32 s59, s59, 1
    s_mul_i32 s60, s59, 0x9e3779b1
    s_xor_b32 s60, s60, 0x5bd1e995
    v_lshrrev_b32 v208, 1, v3
    v_and_b32 v209, 1, v3
    v_lshlrev_b32 v208, 5, v208
    v_lshl_add_u32 v208, v2, 1, v208
    v_add_u32 v208, v208, v209
    v_lshlrev_b32 v206, 4, v208
    s_lshl_b32 s69, s57, 3
    s_add_u32 s69, s69, s58
    s_lshl_b32 s69, s69, 10
    s_add_u32 s69, s69, 4096
    v_mov_b32 v194, s59
    v_mov_b32 v195, s60
    s_waitcnt vmcnt(19)
    v_mfma_f32_16x16x32_bf16 v[188:191], v[100:103], v[20:23], 0
    s_waitcnt vmcnt(18)
    v_mfma_f32_16x16x32_bf16 v[188:191], v[104:107], v[24:27], v[188:191]
    s_waitcnt vmcnt(17)
    v_mfma_f32_16x16x32_bf16 v[188:191], v[108:111], v[28:31], v[188:191]
    s_waitcnt vmcnt(16)
    v_mfma_f32_16x16x32_bf16 v[188:191], v[112:115], v[32:35], v[188:191]
    s_waitcnt vmcnt(15)
    v_mfma_f32_16x16x32_bf16 v[188:191], v[116:119], v[36:39], v[188:191]
    s_waitcnt vmcnt(14)
    v_mfma_f32_16x16x32_bf16 v[188:191], v[120:123], v[40:43], v[188:191]
    s_waitcnt vmcnt(13)
    v_mfma_f32_16x16x32_bf16 v[188:191], v[124:127], v[44:47], v[188:191]
    s_waitcnt vmcnt(12)
    v_mfma_f32_16x16x32_bf16 v[188:191], v[128:131], v[48:51], v[188:191]
    s_waitcnt vmcnt(11)
    v_mfma_f32_16x16x32_bf16 v[188:191], v[132:135], v[52:55], v[188:191]
    s_waitcnt vmcnt(10)
    v_mfma_f32_16x16x32_bf16 v[188:191], v[136:139], v[56:59], v[188:191]
    s_waitcnt vmcnt(9)
    v_mfma_f32_16x16x32_bf16 v[188:191], v[140:143], v[60:63], v[188:191]
    s_waitcnt vmcnt(8)
    v_mfma_f32_16x16x32_bf16 v[188:191], v[144:147], v[64:67], v[188:191]
    s_waitcnt vmcnt(7)
    v_mfma_f32_16x16x32_bf16 v[188:191], v[148:151], v[68:71], v[188:191]
    s_waitcnt vmcnt(6)
    v_mfma_f32_16x16x32_bf16 v[188:191], v[152:155], v[72:75], v[188:191]
    s_waitcnt vmcnt(5)
    v_mfma_f32_16x16x32_bf16 v[188:191], v[156:159], v[76:79], v[188:191]
    s_waitcnt vmcnt(4)
    v_mfma_f32_16x16x32_bf16 v[188:191], v[160:163], v[80:83], v[188:191]
    s_waitcnt vmcnt(3)
    v_mfma_f32_16x16x32_bf16 v[188:191], v[164:167], v[84:87], v[188:191]
    s_waitcnt vmcnt(2)
    v_mfma_f32_16x16x32_bf16 v[188:191], v[168:171], v[88:91], v[188:191]
    s_waitcnt vmcnt(1)
    v_mfma_f32_16x16x32_bf16 v[188:191], v[172:175], v[92:95], v[188:191]
    s_waitcnt vmcnt(0)
    v_mfma_f32_16x16x32_bf16 v[188:191], v[176:179], v[96:99], v[188:191]
    s_cmp_ge_u32 s58, 4
    s_cbranch_scc0 L_nb_6
    s_barrier
L_nb_6:
    s_nop 7
    v_cvt_pk_bf16_f32 v192, v188, v189
    v_cvt_pk_bf16_f32 v193, v190, v191
    s_waitcnt vmcnt(0)
    s_add_u32 s61, s69, 3403776
    buffer_store_dwordx4 v[192:195], v206, s[36:39], s61 offen
    s_cmp_ge_u32 s58, 4
    s_cbranch_scc0 L_qps_7
    buffer_store_dwordx4 v[192:195], v206, s[36:39], s69 offen sc1
L_qps_7:
    s_cmp_ge_u32 s58, 4
    s_cbranch_scc1 L_B
L_P_join:
    s_mov_b32 s44, s12
    s_and_b32 s45, s13, 0xffff
    s_mov_b32 s46, 4194304
    s_mov_b32 s47, 0x00020000
    s_mov_b32 s48, s14
    s_and_b32 s49, s15, 0xffff
    s_mov_b32 s50, 5242880
    s_mov_b32 s51, 0x00020000
    v_and_b32 v188, 7, v2
    v_lshlrev_b32 v188, 10, v188
    v_lshrrev_b32 v189, 3, v2
    v_lshl_add_u32 v188, v189, 9, v188
    v_lshl_add_u32 v164, v3, 5, v188
    s_lshl_b32 s61, s57, 13
    s_lshl_b32 s62, s56, 7
    s_add_u32 s61, s61, s62
    s_add_u32 s61, s61, 4096
    v_lshrrev_b32 v188, 1, v3
    v_lshlrev_b32 v188, 15, v188
    v_and_b32 v189, 1, v3
    v_lshl_add_u32 v188, v189, 5, v188
    v_lshl_add_u32 v165, v2, 1, v188
    s_lshl_b32 s63, s57, 10
    s_lshl_b32 s64, s58, 8
    s_add_u32 s63, s63, s64
    s_lshl_b32 s64, s56, 6
    s_add_u32 s63, s63, s64
    s_add_u32 s63, s63, 266240
    v_lshlrev_b32 v166, 2, v1
    s_lshl_b32 s64, s56, 10
    s_add_u32 s64, s64, 123904
    v_add_u32 v167, s64, v166
    s_lshl_b32 s64, s56, 8
    s_add_u32 s64, s64, 123904
    v_add_u32 v166, s64, v166
    s_mov_b32 s74, 0x55555555
    s_mov_b32 s75, 0x55555555
    s_add_u32 s66, s61, 3403776
    s_waitcnt vmcnt(0)
    s_barrier
    s_lshl_b32 s65, s56, 2
    v_add_u32 v8, s65, v3
    v_xor_b32 v8, v8, v2
    v_lshlrev_b32 v8, 4, v8
    v_lshl_add_u32 v8, v2, 8, v8
    ds_read_b128 v[210:213], v8 offset:32768
    ds_read_b128 v[214:217], v8 offset:36864
    ds_read_b128 v[218:221], v8 offset:40960
    ds_read_b128 v[222:225], v8 offset:45056
    ds_read_b128 v[226:229], v8 offset:49152
    ds_read_b128 v[230:233], v8 offset:53248
    ds_read_b128 v[234:237], v8 offset:57344
    ds_read_b128 v[238:241], v8 offset:61440
    s_mov_b32 s71, 0
    s_mov_b64 s[72:73], exec
    buffer_load_dwordx4 v[10:13], v164, s[36:39], s66 offen sc1
    buffer_load_dwordx4 v[14:17], v164, s[36:39], s66 offen offset:16 sc1
L_qpf_10:
    s_waitcnt vmcnt(0)
    v_xor_b32 v5, s59, v12
    v_xor_b32 v6, s60, v13
    v_or_b32 v4, v5, v6
    v_xor_b32 v5, s59, v16
    v_xor_b32 v6, s60, v17
    v_or3_b32 v4, v4, v5, v6
    v_cmp_ne_u32 vcc, 0, v4
    s_and_b64 exec, exec, vcc
    s_cbranch_execz L_qpd_9_fast
    s_add_u32 s71, s71, 1
    s_cmp_ge_u32 s71, 24
    s_cbranch_scc1 L_qp_8_slow
    buffer_load_dwordx4 v[10:13], v164, s[36:39], s66 offen sc1
    buffer_load_dwordx4 v[14:17], v164, s[36:39], s66 offen offset:16 sc1
    s_branch L_qpf_10
L_qpd_9_fast:
    s_mov_b64 exec, s[72:73]
    s_cmp_eq_u32 s56, 0
    s_cbranch_scc0 L_qpw_11
    buffer_store_dwordx4 v[192:195], v206, s[36:39], s69 offen sc1
L_qpw_11:
    s_branch L_qpd_9
L_qp_8_slow:
    s_mov_b64 s[4:5], exec
    s_mov_b64 exec, s[72:73]
    s_cmp_eq_u32 s56, 0
    s_cbranch_scc0 L_qpw_12
    buffer_store_dwordx4 v[192:195], v206, s[36:39], s69 offen sc1
L_qpw_12:
    s_mov_b64 exec, s[4:5]
    buffer_load_dwordx4 v[10:13], v164, s[36:39], s61 offen sc1
    buffer_load_dwordx4 v[14:17], v164, s[36:39], s61 offen offset:16 sc1
L_qp_8:
    s_waitcnt vmcnt(0)
    v_xor_b32 v5, s59, v12
    v_xor_b32 v6, s60, v13
    v_or_b32 v4, v5, v6
    v_xor_b32 v5, s59, v16
    v_xor_b32 v6, s60, v17
    v_or3_b32 v4, v4, v5, v6
    v_cmp_ne_u32 vcc, 0, v4
    s_and_b64 exec, exec, vcc
    s_cbranch_execz L_qpd_9
    s_add_u32 s71, s71, 1
    s_cmp_ge_u32 s71, 100000
    s_cbranch_scc1 L_qpd_9
    buffer_load_dwordx4 v[10:13], v164, s[36:39], s61 offen sc1
    buffer_load_dwordx4 v[14:17], v164, s[36:39], s61 offen offset:16 sc1
    s_branch L_qp_8
L_qpd_9:
    s_mov_b64 exec, s[72:73]
    s_waitcnt lgkmcnt(0)
    v_mov_b32 v12, v14
    v_mov_b32 v13, v15
    s_nop 1
    v_mfma_f32_16x16x32_bf16 v[28:31], v[10:13], v[210:213], 0
    v_mfma_f32_16x16x32_bf16 v[32:35], v[10:13], v[214:217], 0
    v_mfma_f32_16x16x32_bf16 v[36:39], v[10:13], v[218:221], 0
    v_mfma_f32_16x16x32_bf16 v[40:43], v[10:13], v[222:225], 0
    v_mfma_f32_16x16x32_bf16 v[44:47], v[10:13], v[226:229], 0
    v_mfma_f32_16x16x32_bf16 v[48:51], v[10:13], v[230:233], 0
    v_mfma_f32_16x16x32_bf16 v[52:55], v[10:13], v[234:237], 0
    v_mfma_f32_16x16x32_bf16 v[56:59], v[10:13], v[238:241], 0
    s_nop 0
    v_add_f32 v28, v28, v29
    v_add_f32 v30, v30, v31
    v_add_f32 v28, v28, v30
    v_add_f32 v32, v32, v33
    v_add_f32 v34, v34, v35
    v_add_f32 v32, v32, v34
    v_add_f32 v36, v36, v37
    v_add_f32 v38, v38, v39
    v_add_f32 v36, v36, v38
    v_add_f32 v40, v40, v41
    v_add_f32 v42, v42, v43
    v_add_f32 v40, v40, v42
    v_add_f32 v44, v44, v45
    v_add_f32 v46, v46, v47
    v_add_f32 v44, v44, v46
    v_add_f32 v48, v48, v49
    v_add_f32 v50, v50, v51
    v_add_f32 v48, v48, v50
    v_add_f32 v52, v52, v53
    v_add_f32 v54, v54, v55
    v_add_f32 v52, v52, v54
    v_add_f32 v56, v56, v57
    v_add_f32 v58, v58, v59
    v_add_f32 v56, v56, v58
    s_nop 1
    v_permlane16_swap_b32 v28, v32
    v_permlane16_swap_b32 v36, v40
    v_permlane16_swap_b32 v44, v48
    v_permlane16_swap_b32 v52, v56
    s_nop 0
    v_add_f32 v68, v28, v32
    v_add_f32 v69, v36, v40
    v_add_f32 v70, v44, v48
    v_add_f32 v71, v52, v56
    ds_write2st64_b32 v167, v68, v69 offset0:0 offset1:1
    ds_write2st64_b32 v167, v70, v71 offset0:2 offset1:3
    s_waitcnt lgkmcnt(0)
    s_barrier
    ds_read2st64_b32 v[188:189], v166 offset0:0 offset1:4
    ds_read2st64_b32 v[190:191], v166 offset0:8 offset1:12
    s_waitcnt lgkmcnt(0)
    v_add_f32 v188, v188, v189
    v_add_f32 v190, v190, v191
    v_add_f32 v188, v188, v190
    v_mul_f32 v188, 0x3e0293ee, v188
    s_nop 1
    v_mov_b32_dpp v189, v188 quad_perm:[1,0,3,2] row_mask:0xf bank_mask:0xf
    v_cvt_pk_bf16_f32 v188, v188, v189
    s_mov_b64 exec, s[74:75]
    buffer_store_dword v188, v165, s[36:39], s63 offen sc1
    s_mov_b64 exec, -1
    s_cmp_lt_u32 s57, 27
    s_cbranch_scc0 L_P_nof1
    s_mov_b32 s32, s18
    s_and_b32 s33, s19, 0xffff
    s_mov_b32 s34, 2211840
    s_mov_b32 s35, 0x00020000
    v_lshrrev_b32 v188, 3, v1
    v_mul_u32_u24 v188, 3456, v188
    v_and_b32 v189, 7, v1
    v_lshl_add_u32 v188, v189, 4, v188
    s_mul_i32 s61, s58, 552960
    s_mul_i32 s62, s56, 138240
    s_add_u32 s61, s61, s62
    s_lshl_b32 s62, s57, 7
    s_add_u32 s61, s61, s62
    s_mul_i32 s62, s56, 5120
    s_add_u32 s62, s62, 130560
    s_mov_b32 m0, s62
    s_add_u32 s62, s62, 1024
    buffer_load_dwordx4 v188, s[32:35], s61 offen lds
    s_add_u32 s61, s61, 27648
    s_mov_b32 m0, s62
    s_add_u32 s62, s62, 1024
    buffer_load_dwordx4 v188, s[32:35], s61 offen lds
    s_add_u32 s61, s61, 27648
    s_mov_b32 m0, s62
    s_add_u32 s62, s62, 1024
    buffer_load_dwordx4 v188, s[32:35], s61 offen lds
    s_add_u32 s61, s61, 27648
    s_mov_b32 m0, s62
    s_add_u32 s62, s62, 1024
    buffer_load_dwordx4 v188, s[32:35], s61 offen lds
    s_add_u32 s61, s61, 27648
    s_mov_b32 m0, s62
    s_add_u32 s62, s62, 1024
    buffer_load_dwordx4 v188, s[32:35], s61 offen lds
    s_add_u32 s61, s61, 27648
L_P_nof1:
    v_add_u32 v188, 0, v3
    v_lshlrev_b32 v188, 1, v188
    v_xor_b32 v188, v188, v2
    v_lshlrev_b32 v188, 4, v188
    v_lshl_add_u32 v168, v3, 13, v188
    v_add_u32 v188, 4, v3
    v_lshlrev_b32 v188, 1, v188
    v_xor_b32 v188, v188, v2
    v_lshlrev_b32 v188, 4, v188
    v_lshl_add_u32 v169, v3, 13, v188
    s_mul_i32 s61, s58, 1048576
    s_lshl_b32 s62, s57, 8
    s_add_u32 s61, s61, s62
    s_lshl_b32 s62, s56, 18
    s_add_u32 s61, s61, s62
    s_lshl_b32 s62, s56, 13
    s_add_u32 s62, s62, 0
    s_mov_b32 m0, s62
    s_add_u32 s62, s62, 1024
    buffer_load_dwordx4 v168, s[44:47], s61 offen lds
    s_add_u32 s61, s61, 32768
    s_mov_b32 m0, s62
    s_add_u32 s62, s62, 1024
    buffer_load_dwordx4 v169, s[44:47], s61 offen lds
    s_add_u32 s61, s61, 32768
    s_mov_b32 m0, s62
    s_add_u32 s62, s62, 1024
    buffer_load_dwordx4 v168, s[44:47], s61 offen lds
    s_add_u32 s61, s61, 32768
    s_mov_b32 m0, s62
    s_add_u32 s62, s62, 1024
    buffer_load_dwordx4 v169, s[44:47], s61 offen lds
    s_add_u32 s61, s61, 32768
    s_mov_b32 m0, s62
    s_add_u32 s62, s62, 1024
    buffer_load_dwordx4 v168, s[44:47], s61 offen lds
    s_add_u32 s61, s61, 32768
    s_mov_b32 m0, s62
    s_add_u32 s62, s62, 1024
    buffer_load_dwordx4 v169, s[44:47], s61 offen lds
    s_add_u32 s61, s61, 32768
    s_mov_b32 m0, s62
    s_add_u32 s62, s62, 1024
    buffer_load_dwordx4 v168, s[44:47], s61 offen lds
    s_add_u32 s61, s61, 32768
    s_mov_b32 m0, s62
    s_add_u32 s62, s62, 1024
    buffer_load_dwordx4 v169, s[44:47], s61 offen lds
    s_add_u32 s61, s61, 32768
    s_mul_i32 s61, s57, 163840
    s_mul_i32 s62, s58, 320
    s_add_u32 s61, s61, s62
    s_mul_i32 s62, s56, 640
    v_add_u32 v188, s62, v1
    s_mul_i32 s62, s56, 10240
    s_add_u32 s62, s62, 66560
    s_movk_i32 s63, 3277
    s_movk_i32 s64, 960
    v_mul_u32_u24 v189, s63, v188
    v_lshrrev_b32 v189, 16, v189
    v_mul_u32_u24 v189, s64, v189
    v_lshl_add_u32 v190, v188, 4, v189
    s_mov_b32 m0, s62
    s_add_u32 s62, s62, 1024
    buffer_load_dwordx4 v190, s[48:51], s61 offen lds
    v_add_u32 v188, 64, v188
    v_mul_u32_u24 v189, s63, v188
    v_lshrrev_b32 v189, 16, v189
    v_mul_u32_u24 v189, s64, v189
    v_lshl_add_u32 v191, v188, 4, v189
    s_mov_b32 m0, s62
    s_add_u32 s62, s62, 1024
    buffer_load_dwordx4 v191, s[48:51], s61 offen lds
    v_add_u32 v188, 64, v188
    v_mul_u32_u24 v189, s63, v188
    v_lshrrev_b32 v189, 16, v189
    v_mul_u32_u24 v189, s64, v189
    v_lshl_add_u32 v190, v188, 4, v189
    s_mov_b32 m0, s62
    s_add_u32 s62, s62, 1024
    buffer_load_dwordx4 v190, s[48:51], s61 offen lds
    v_add_u32 v188, 64, v188
    v_mul_u32_u24 v189, s63, v188
    v_lshrrev_b32 v189, 16, v189
    v_mul_u32_u24 v189, s64, v189
    v_lshl_add_u32 v191, v188, 4, v189
    s_mov_b32 m0, s62
    s_add_u32 s62, s62, 1024
    buffer_load_dwordx4 v191, s[48:51], s61 offen lds
    v_add_u32 v188, 64, v188
    v_mul_u32_u24 v189, s63, v188
    v_lshrrev_b32 v189, 16, v189
    v_mul_u32_u24 v189, s64, v189
    v_lshl_add_u32 v190, v188, 4, v189
    s_mov_b32 m0, s62
    s_add_u32 s62, s62, 1024
    buffer_load_dwordx4 v190, s[48:51], s61 offen lds
    v_add_u32 v188, 64, v188
    v_mul_u32_u24 v189, s63, v188
    v_lshrrev_b32 v189, 16, v189
    v_mul_u32_u24 v189, s64, v189
    v_lshl_add_u32 v191, v188, 4, v189
    s_mov_b32 m0, s62
    s_add_u32 s62, s62, 1024
    buffer_load_dwordx4 v191, s[48:51], s61 offen lds
    v_add_u32 v188, 64, v188
    v_mul_u32_u24 v189, s63, v188
    v_lshrrev_b32 v189, 16, v189
    v_mul_u32_u24 v189, s64, v189
    v_lshl_add_u32 v190, v188, 4, v189
    s_mov_b32 m0, s62
    s_add_u32 s62, s62, 1024
    buffer_load_dwordx4 v190, s[48:51], s61 offen lds
    v_add_u32 v188, 64, v188
    v_mul_u32_u24 v189, s63, v188
    v_lshrrev_b32 v189, 16, v189
    v_mul_u32_u24 v189, s64, v189
    v_lshl_add_u32 v191, v188, 4, v189
    s_mov_b32 m0, s62
    s_add_u32 s62, s62, 1024
    buffer_load_dwordx4 v191, s[48:51], s61 offen lds
    v_add_u32 v188, 64, v188
    v_mul_u32_u24 v189, s63, v188
    v_lshrrev_b32 v189, 16, v189
    v_mul_u32_u24 v189, s64, v189
    v_lshl_add_u32 v190, v188, 4, v189
    s_mov_b32 m0, s62
    s_add_u32 s62, s62, 1024
    buffer_load_dwordx4 v190, s[48:51], s61 offen lds
    v_add_u32 v188, 64, v188
    v_mul_u32_u24 v189, s63, v188
    v_lshrrev_b32 v189, 16, v189
    v_mul_u32_u24 v189, s64, v189
    v_lshl_add_u32 v191, v188, 4, v189
    s_mov_b32 m0, s62
    s_add_u32 s62, s62, 1024
    buffer_load_dwordx4 v191, s[48:51], s61 offen lds
    v_add_u32 v188, 64, v188
    v_bfe_u32 v188, v1, 3, 1
    v_bfe_u32 v189, v1, 2, 1
    v_and_b32 v190, 3, v1
    v_lshlrev_b32 v189, 4, v189
    v_lshl_add_u32 v189, v3, 2, v189
    v_add_u32 v189, v189, v190
    v_lshl_add_u32 v189, v188, 5, v189
    v_lshlrev_b32 v173, 3, v189
    v_and_b32 v189, 1, v1
    v_cmp_eq_u32 vcc, 1, v189
    v_mov_b32 v190, 0xffff
    v_mov_b32 v191, 0xffff0000
    v_cndmask_b32 v190, v190, v191, vcc
    v_bfe_u32 v189, v1, 1, 2
    v_lshl_add_u32 v189, v188, 2, v189
    v_cmp_eq_u32 vcc, 0, v189
    s_nop 1
    v_cndmask_b32 v180, 0, v190, vcc
    v_cmp_eq_u32 vcc, 1, v189
    s_nop 1
    v_cndmask_b32 v181, 0, v190, vcc
    v_cmp_eq_u32 vcc, 2, v189
    s_nop 1
    v_cndmask_b32 v182, 0, v190, vcc
    v_cmp_eq_u32 vcc, 3, v189
    s_nop 1
    v_cndmask_b32 v183, 0, v190, vcc
    v_cmp_eq_u32 vcc, 4, v189
    s_nop 1
    v_cndmask_b32 v184, 0, v190, vcc
    v_cmp_eq_u32 vcc, 5, v189
    s_nop 1
    v_cndmask_b32 v185, 0, v190, vcc
    v_cmp_eq_u32 vcc, 6, v189
    s_nop 1
    v_cndmask_b32 v186, 0, v190, vcc
    v_cmp_eq_u32 vcc, 7, v189
    s_nop 1
    v_cndmask_b32 v187, 0, v190, vcc
    v_lshlrev_b32 v174, 4, v0
    v_lshrrev_b32 v188, 4, v0
    v_and_b32 v189, 7, v188
    v_lshlrev_b32 v189, 1, v189
    v_xor_b32 v189, v189, v2
    v_lshlrev_b32 v189, 4, v189
    v_lshl_add_u32 v189, v188, 8, v189
    v_add_u32 v175, 107520, v189
    v_lshrrev_b32 v188, 2, v2
    v_lshl_add_u32 v188, v3, 2, v188
    v_and_b32 v189, 7, v188
    v_lshlrev_b32 v189, 1, v189
    v_bfe_u32 v190, v2, 1, 1
    v_and_b32 v191, 1, v2
    s_lshl_b32 s61, s56, 2
    v_add_u32 v192, s61, v190
    v_xor_b32 v192, v192, v189
    v_lshlrev_b32 v192, 4, v192
    v_lshl_add_u32 v192, v191, 3, v192
    v_lshl_add_u32 v192, v188, 8, v192
    v_add_u32 v176, 107520, v192
    v_add_u32 v192, s61, v190
    v_add_u32 v192, 2, v192
    v_xor_b32 v192, v192, v189
    v_lshlrev_b32 v192, 4, v192
    v_lshl_add_u32 v192, v191, 3, v192
    v_lshl_add_u32 v192, v188, 8, v192
    v_add_u32 v177, 107520, v192
    v_lshrrev_b32 v188, 1, v3
    v_and_b32 v189, 1, v3
    v_lshlrev_b32 v188, 7, v188
    v_lshl_add_u32 v188, v189, 4, v188
    v_add_u32 v188, v188, v2
    s_lshl_b32 s61, s56, 5
    v_add_u32 v188, s61, v188
    v_lshlrev_b32 v188, 1, v188
    v_add_u32 v178, 129024, v188
    v_and_b32 v188, 1, v1
    v_lshlrev_b32 v188, 8, v188
    v_lshl_add_u32 v188, v3, 4, v188
    v_add_u32 v179, 129024, v188
    s_cmp_lt_u32 s57, 27
    s_cbranch_scc0 L_P_nof2
    v_and_b32 v188, 1, v1
    v_mul_u32_u24 v188, 1280, v188
    v_lshl_add_u32 v188, v3, 3, v188
    s_mul_i32 s61, s58, 320
    s_add_u32 s61, s61, 152064
    v_add_u32 v188, s61, v188
    ds_read_b64 v[28:29], v188 offset:0
    ds_read_b64 v[30:31], v188 offset:32
    ds_read_b64 v[32:33], v188 offset:64
    ds_read_b64 v[34:35], v188 offset:96
    ds_read_b64 v[36:37], v188 offset:128
    ds_read_b64 v[38:39], v188 offset:160
    ds_read_b64 v[40:41], v188 offset:192
    ds_read_b64 v[42:43], v188 offset:224
    ds_read_b64 v[44:45], v188 offset:256
    ds_read_b64 v[46:47], v188 offset:288
    v_lshrrev_b32 v189, 2, v2
    v_lshl_add_u32 v189, v3, 2, v189
    v_lshlrev_b32 v189, 7, v189
    v_and_b32 v190, 3, v2
    v_lshl_add_u32 v189, v190, 3, v189
    s_lshl_b32 s61, s56, 5
    s_add_u32 s61, s61, 130560
    v_add_u32 v189, s61, v189
    v_lshlrev_b32 v190, 4, v2
    s_lshl_b32 s61, s57, 2
    s_add_u32 s61, s61, s58
    s_lshl_b32 s61, s61, 10
    s_lshl_b32 s62, s56, 8
    s_add_u32 s61, s61, s62
    s_add_u32 s61, s61, 3145728
    s_waitcnt vmcnt(18)
    s_barrier
    ds_read_b64_tr_b16 v[48:49], v189 offset:0
    ds_read_b64_tr_b16 v[50:51], v189 offset:2048
    ds_read_b64_tr_b16 v[52:53], v189 offset:4096
    ds_read_b64_tr_b16 v[54:55], v189 offset:6144
    ds_read_b64_tr_b16 v[56:57], v189 offset:8192
    ds_read_b64_tr_b16 v[58:59], v189 offset:10240
    ds_read_b64_tr_b16 v[60:61], v189 offset:12288
    ds_read_b64_tr_b16 v[62:63], v189 offset:14336
    ds_read_b64_tr_b16 v[64:65], v189 offset:16384
    ds_read_b64_tr_b16 v[66:67], v189 offset:18432
    s_waitcnt lgkmcnt(0)
    v_mfma_f32_16x16x32_bf16 v[68:71], v[28:31], v[48:51], 0
    v_mfma_f32_16x16x32_bf16 v[68:71], v[32:35], v[52:55], v[68:71]
    v_mfma_f32_16x16x32_bf16 v[68:71], v[36:39], v[56:59], v[68:71]
    v_mfma_f32_16x16x32_bf16 v[68:71], v[40:43], v[60:63], v[68:71]
    v_mfma_f32_16x16x32_bf16 v[68:71], v[44:47], v[64:67], v[68:71]
    s_nop 7
    v_mov_b32 v70, s59
    v_mov_b32 v71, s60
    s_mov_b64 exec, 0xffff
    buffer_store_dwordx4 v[68:71], v190, s[36:39], s61 offen sc1
    s_mov_b64 exec, -1
    s_waitcnt vmcnt(1)
    s_branch L_P_wl
L_P_nof2:
    s_waitcnt vmcnt(0)
L_P_wl:
    s_barrier
    v_lshrrev_b32 v188, 2, v2
    v_and_b32 v189, 3, v2
    v_lshl_add_u32 v190, v3, 2, v188
    v_and_b32 v191, 7, v190
    v_lshlrev_b32 v191, 1, v191
    v_lshrrev_b32 v192, 1, v189
    v_and_b32 v193, 1, v189
    s_lshl_b32 s61, s56, 2
    v_add_u32 v194, s61, v192
    v_xor_b32 v194, v194, v191
    v_lshlrev_b32 v194, 4, v194
    v_lshl_add_u32 v194, v193, 3, v194
    v_lshl_add_u32 v170, v190, 8, v194
    v_add_u32 v194, s61, v192
    v_add_u32 v194, 2, v194
    v_xor_b32 v194, v194, v191
    v_lshlrev_b32 v194, 4, v194
    v_lshl_add_u32 v194, v193, 3, v194
    v_lshl_add_u32 v171, v190, 8, v194
    ds_read_b64_tr_b16 v[76:77], v170 offset:0
    ds_read_b64_tr_b16 v[78:79], v170 offset:4096
    ds_read_b64_tr_b16 v[80:81], v170 offset:8192
    ds_read_b64_tr_b16 v[82:83], v170 offset:12288
    ds_read_b64_tr_b16 v[84:85], v170 offset:16384
    ds_read_b64_tr_b16 v[86:87], v170 offset:20480
    ds_read_b64_tr_b16 v[88:89], v170 offset:24576
    ds_read_b64_tr_b16 v[90:91], v170 offset:28672
    ds_read_b64_tr_b16 v[92:93], v171 offset:0
    ds_read_b64_tr_b16 v[94:95], v171 offset:4096
    ds_read_b64_tr_b16 v[96:97], v171 offset:8192
    ds_read_b64_tr_b16 v[98:99], v171 offset:12288
    ds_read_b64_tr_b16 v[100:101], v171 offset:16384
    ds_read_b64_tr_b16 v[102:103], v171 offset:20480
    ds_read_b64_tr_b16 v[104:105], v171 offset:24576
    ds_read_b64_tr_b16 v[106:107], v171 offset:28672
    v_lshrrev_b32 v188, 2, v2
    v_and_b32 v189, 3, v2
    v_lshl_add_u32 v190, v3, 2, v188
    s_lshl_b32 s61, s56, 5
    v_add_u32 v194, s61, v190
    v_mul_u32_u24 v194, 320, v194
    v_lshl_add_u32 v172, v189, 3, v194
    v_add_u32 v172, 66560, v172
    ds_read_b64_tr_b16 v[108:109], v172 offset:0
    ds_read_b64_tr_b16 v[110:111], v172 offset:5120
    ds_read_b64_tr_b16 v[112:113], v172 offset:32
    ds_read_b64_tr_b16 v[114:115], v172 offset:5152
    ds_read_b64_tr_b16 v[116:117], v172 offset:64
    ds_read_b64_tr_b16 v[118:119], v172 offset:5184
    ds_read_b64_tr_b16 v[120:121], v172 offset:96
    ds_read_b64_tr_b16 v[122:123], v172 offset:5216
    ds_read_b64_tr_b16 v[124:125], v172 offset:128
    ds_read_b64_tr_b16 v[126:127], v172 offset:5248
    ds_read_b64_tr_b16 v[128:129], v172 offset:160
    ds_read_b64_tr_b16 v[130:131], v172 offset:5280
    ds_read_b64_tr_b16 v[132:133], v172 offset:192
    ds_read_b64_tr_b16 v[134:135], v172 offset:5312
    ds_read_b64_tr_b16 v[136:137], v172 offset:224
    ds_read_b64_tr_b16 v[138:139], v172 offset:5344
    ds_read_b64_tr_b16 v[140:141], v172 offset:256
    ds_read_b64_tr_b16 v[142:143], v172 offset:5376
    ds_read_b64_tr_b16 v[144:145], v172 offset:288
    ds_read_b64_tr_b16 v[146:147], v172 offset:5408
    s_lshl_b32 s61, s57, 9
    s_add_u32 s61, s61, 331776
    s_lshl_b32 s62, s57, 2
    s_add_u32 s62, s62, s58
    s_lshl_b32 s63, s62, 14
    s_add_u32 s63, s63, 1048576
    s_add_u32 s64, s63, 4096
    s_add_u32 s65, s63, 8192
    s_add_u32 s66, s63, 12288
    v_lshlrev_b32 v200, 3, v1
    v_add_u32 v200, 129536, v200
    s_cmp_eq_u32 s56, 0
    s_cbranch_scc0 L_stw_13
    s_mov_b32 s71, 0
    s_mov_b64 s[72:73], exec
    buffer_load_dwordx2 v[26:27], v173, s[36:39], s61 offen sc1
L_st_14:
    s_waitcnt vmcnt(0)
    v_max_u32 v4, v26, v27
    v_cmp_eq_u32 vcc, -1, v4
    s_and_b64 exec, exec, vcc
    s_cbranch_execz L_std_15
    s_add_u32 s71, s71, 1
    s_cmp_ge_u32 s71, 100000
    s_cbranch_scc1 L_std_15
    buffer_load_dwordx2 v[26:27], v173, s[36:39], s61 offen sc1
    s_branch L_st_14
L_std_15:
    s_mov_b64 exec, s[72:73]
    ds_write_b64 v200, v[26:27]
    s_waitcnt lgkmcnt(0)
L_stw_13:
    s_barrier
    ds_read_b64 v[26:27], v200
    s_waitcnt lgkmcnt(0)
    v_mov_b32 v196, v26
    s_nop 1
    v_max_f32_dpp v196, v196, v196 quad_perm:[1,0,3,2] row_mask:0xf bank_mask:0xf
    s_nop 1
    v_max_f32_dpp v196, v196, v196 quad_perm:[2,3,0,1] row_mask:0xf bank_mask:0xf
    s_nop 1
    v_max_f32_dpp v196, v196, v196 row_half_mirror row_mask:0xf bank_mask:0xf
    v_mov_b32 v197, v196
    s_nop 1
    v_permlane16_swap_b32 v196, v197
    s_nop 0
    v_max_f32 v196, v196, v197
    v_mov_b32 v197, v196
    s_nop 1
    v_permlane32_swap_b32 v196, v197
    s_nop 0
    v_max_f32 v196, v196, v197
    v_sub_f32 v188, v26, v196
    v_exp_f32 v188, v188
    s_nop 0
    v_cvt_pk_bf16_f32 v188, v188, v188
    v_and_b32 v148, v188, v180
    v_and_b32 v149, v188, v181
    v_and_b32 v150, v188, v182
    v_and_b32 v151, v188, v183
    v_and_b32 v152, v188, v184
    v_and_b32 v153, v188, v185
    v_and_b32 v154, v188, v186
    v_and_b32 v155, v188, v187
    v_and_b32 v189, 0xffff0000, v188
    v_mul_f32 v189, v189, v27
    buffer_load_dwordx4 v[10:13], v174, s[36:39], s63 offen sc1
    buffer_load_dwordx4 v[14:17], v174, s[36:39], s64 offen sc1
    buffer_load_dwordx4 v[18:21], v174, s[36:39], s65 offen sc1
    buffer_load_dwordx4 v[22:25], v174, s[36:39], s66 offen sc1
    s_nop 1
    v_add_f32_dpp v189, v189, v189 quad_perm:[1,0,3,2] row_mask:0xf bank_mask:0xf
    s_nop 1
    v_add_f32_dpp v189, v189, v189 quad_perm:[2,3,0,1] row_mask:0xf bank_mask:0xf
    s_nop 1
    v_add_f32_dpp v189, v189, v189 row_half_mirror row_mask:0xf bank_mask:0xf
    v_mov_b32 v197, v189
    s_nop 1
    v_permlane16_swap_b32 v189, v197
    s_nop 0
    v_add_f32 v189, v189, v197
    v_mov_b32 v197, v189
    s_nop 1
    v_permlane32_swap_b32 v189, v197
    s_nop 0
    v_add_f32 v189, v189, v197
    v_rcp_f32 v189, v189
    s_nop 0
    v_readlane_b32 s67, v189, 0
    v_readlane_b32 s68, v189, 8
    v_cmp_le_u32 vcc, 32, v1
    s_nop 0
    v_mov_b32 v190, s67
    v_mov_b32 v191, s68
    v_cndmask_b32 v190, v190, v191, vcc
    s_mov_b32 s71, 0
    s_mov_b64 s[72:73], exec
L_ao_16:
    s_waitcnt vmcnt(0)
    v_max3_u32 v4, v10, v11, v12
    v_max3_u32 v4, v4, v13, v14
    v_max3_u32 v4, v4, v15, v16
    v_max3_u32 v4, v4, v17, v18
    v_max3_u32 v4, v4, v19, v20
    v_max3_u32 v4, v4, v21, v22
    v_max3_u32 v4, v4, v23, v24
    v_max_u32 v4, v4, v25
    v_cmp_eq_u32 vcc, -1, v4
    s_and_b64 exec, exec, vcc
    s_cbranch_execz L_aod_17
    s_add_u32 s71, s71, 1
    s_cmp_ge_u32 s71, 100000
    s_cbranch_scc1 L_aod_17
    buffer_load_dwordx4 v[10:13], v174, s[36:39], s63 offen sc1
    buffer_load_dwordx4 v[14:17], v174, s[36:39], s64 offen sc1
    buffer_load_dwordx4 v[18:21], v174, s[36:39], s65 offen sc1
    buffer_load_dwordx4 v[22:25], v174, s[36:39], s66 offen sc1
    s_branch L_ao_16
L_aod_17:
    s_mov_b64 exec, s[72:73]
    ds_write_b128 v175, v[10:13] offset:0
    ds_write_b128 v175, v[14:17] offset:4096
    ds_write_b128 v175, v[18:21] offset:8192
    ds_write_b128 v175, v[22:25] offset:12288
    s_waitcnt lgkmcnt(0)
    s_barrier
    ds_read_b64_tr_b16 v[36:37], v176 offset:0
    ds_read_b64_tr_b16 v[38:39], v176 offset:4096
    ds_read_b64_tr_b16 v[40:41], v176 offset:8192
    ds_read_b64_tr_b16 v[42:43], v176 offset:12288
    ds_read_b64_tr_b16 v[44:45], v177 offset:0
    ds_read_b64_tr_b16 v[46:47], v177 offset:4096
    ds_read_b64_tr_b16 v[48:49], v177 offset:8192
    ds_read_b64_tr_b16 v[50:51], v177 offset:12288
    s_waitcnt lgkmcnt(4)
    v_mfma_f32_16x16x32_bf16 v[28:31], v[148:151], v[36:39], 0
    v_mfma_f32_16x16x32_bf16 v[28:31], v[152:155], v[40:43], v[28:31]
    s_waitcnt lgkmcnt(0)
    v_mfma_f32_16x16x32_bf16 v[32:35], v[148:151], v[44:47], 0
    v_mfma_f32_16x16x32_bf16 v[32:35], v[152:155], v[48:51], v[32:35]
    s_nop 7
    v_add_f32 v28, v28, v29
    v_add_f32 v30, v30, v31
    v_add_f32 v32, v32, v33
    v_add_f32 v34, v34, v35
    v_add_f32 v28, v28, v30
    v_add_f32 v32, v32, v34
    s_nop 1
    v_permlane16_swap_b32 v28, v32
    s_nop 0
    v_add_f32 v28, v28, v32
    v_mul_f32 v28, v28, v190
    v_cvt_pk_bf16_f32 v28, v28, v28
    ds_write_b16 v178, v28
    s_waitcnt lgkmcnt(0)
    s_barrier
    ds_read_b128 v[148:151], v179 offset:0
    ds_read_b128 v[152:155], v179 offset:64
    ds_read_b128 v[156:159], v179 offset:128
    ds_read_b128 v[160:163], v179 offset:192
    v_lshrrev_b32 v188, 2, v2
    v_lshlrev_b32 v188, 3, v188
    v_and_b32 v189, 1, v3
    v_lshl_add_u32 v188, v189, 2, v188
    v_and_b32 v189, 2, v2
    v_add_u32 v188, v188, v189
    v_lshrrev_b32 v189, 1, v3
    v_lshl_add_u32 v188, v189, 7, v188
    v_lshlrev_b32 v188, 1, v188
    s_lshl_b32 s61, s57, 2
    s_add_u32 s61, s61, s58
    s_lshl_b32 s61, s61, 9
    s_lshl_b32 s62, s56, 6
    s_add_u32 s61, s61, s62
    s_add_u32 s61, s61, 348160
    s_add_u32 s62, s61, 602112
    s_mov_b32 s74, 0xffff0000
    s_mov_b32 s75, 0xffff0000
    s_mov_b32 s76, 0
    s_mov_b32 s77, -1
    s_mov_b32 s78, 0x55555555
    s_mov_b32 s79, 0x55555555
    s_waitcnt lgkmcnt(3)
    v_mfma_f32_16x16x32_bf16 v[28:31], v[148:151], v[76:79], 0
    v_mfma_f32_16x16x32_bf16 v[32:35], v[148:151], v[92:95], 0
    s_waitcnt lgkmcnt(2)
    v_mfma_f32_16x16x32_bf16 v[28:31], v[152:155], v[80:83], v[28:31]
    v_mfma_f32_16x16x32_bf16 v[32:35], v[152:155], v[96:99], v[32:35]
    s_waitcnt lgkmcnt(1)
    v_mfma_f32_16x16x32_bf16 v[28:31], v[156:159], v[84:87], v[28:31]
    v_mfma_f32_16x16x32_bf16 v[32:35], v[156:159], v[100:103], v[32:35]
    s_waitcnt lgkmcnt(0)
    v_mfma_f32_16x16x32_bf16 v[28:31], v[160:163], v[88:91], v[28:31]
    v_mfma_f32_16x16x32_bf16 v[32:35], v[160:163], v[104:107], v[32:35]
    s_nop 7
    v_cndmask_b32 v190, v28, v32, s[74:75]
    v_cndmask_b32 v191, v29, v33, s[74:75]
    v_cndmask_b32 v190, v190, v191, s[76:77]
    s_nop 1
    v_mov_b32_dpp v191, v190 quad_perm:[1,0,3,2] row_mask:0xf bank_mask:0xf
    v_cvt_pk_bf16_f32 v190, v190, v191
    v_mov_b32 v206, v190
    v_mov_b32 v207, v188
    s_mov_b32 s16, s61
    s_mov_b64 exec, s[78:79]
    buffer_store_dword v190, v188, s[36:39], s62 offen
    s_mov_b64 exec, -1
    v_and_b32 v188, 3, v2
    v_lshlrev_b32 v188, 9, v188
    v_bfe_u32 v189, v2, 2, 1
    v_lshl_add_u32 v188, v189, 8, v188
    v_lshl_add_u32 v164, v3, 4, v188
    s_lshl_b32 s61, s57, 11
    s_lshl_b32 s62, s56, 6
    s_add_u32 s61, s61, s62
    s_add_u32 s61, s61, 348160
    v_lshrrev_b32 v188, 1, v3
    v_lshlrev_b32 v188, 4, v188
    v_add_u32 v188, v188, v2
    v_lshlrev_b32 v188, 3, v188
    v_and_b32 v189, 1, v3
    v_lshl_add_u32 v165, v189, 2, v188
    s_mul_i32 s62, s57, 5120
    s_mul_i32 s63, s58, 1280
    s_add_u32 s62, s62, s63
    s_add_u32 s62, s62, 413696
    s_lshl_b32 s63, s56, 8
    s_add_u32 s63, s63, s62
    s_add_u32 s62, s62, 1024
    v_lshlrev_b32 v188, 2, v1
    s_mul_i32 s64, s56, 1280
    s_add_u32 s64, s64, 123904
    v_add_u32 v167, s64, v188
    s_lshl_b32 s64, s56, 8
    s_add_u32 s64, s64, 123904
    v_add_u32 v166, s64, v188
    v_add_u32 v168, 124928, v188
    s_mov_b32 s76, 0
    s_mov_b32 s77, -1
    s_add_u32 s66, s61, 602112
    s_mov_b32 s71, 0
    s_mov_b64 s[72:73], exec
    buffer_load_dwordx4 v[10:13], v164, s[36:39], s66 offen sc1
L_cpf_20:
    s_waitcnt vmcnt(0)
    v_max3_u32 v4, v10, v11, v12
    v_max_u32 v4, v4, v13
    v_cmp_eq_u32 vcc, -1, v4
    s_and_b64 exec, exec, vcc
    s_cbranch_execz L_cpd_19_fast
    s_add_u32 s71, s71, 1
    s_cmp_ge_u32 s71, 16
    s_cbranch_scc1 L_cp_18_slow
    buffer_load_dwordx4 v[10:13], v164, s[36:39], s66 offen sc1
    s_branch L_cpf_20
L_cpd_19_fast:
    s_mov_b64 exec, s[72:73]
    s_mov_b32 exec_lo, 0x55555555
    s_mov_b32 exec_hi, 0x55555555
    buffer_store_dword v206, v207, s[36:39], s16 offen sc1
    s_mov_b64 exec, -1
    s_branch L_cpd_19
L_cp_18_slow:
    s_mov_b64 s[4:5], exec
    s_mov_b64 exec, s[72:73]
    s_mov_b32 exec_lo, 0x55555555
    s_mov_b32 exec_hi, 0x55555555
    buffer_store_dword v206, v207, s[36:39], s16 offen sc1
    s_mov_b64 exec, -1
    s_mov_b64 exec, s[4:5]
    buffer_load_dwordx4 v[10:13], v164, s[36:39], s61 offen sc1
L_cp_18:
    s_waitcnt vmcnt(0)
    v_max3_u32 v4, v10, v11, v12
    v_max_u32 v4, v4, v13
    v_cmp_eq_u32 vcc, -1, v4
    s_and_b64 exec, exec, vcc
    s_cbranch_execz L_cpd_19
    s_add_u32 s71, s71, 1
    s_cmp_ge_u32 s71, 100000
    s_cbranch_scc1 L_cpd_19
    buffer_load_dwordx4 v[10:13], v164, s[36:39], s61 offen sc1
    s_branch L_cp_18
L_cpd_19:
    s_mov_b64 exec, s[72:73]
    v_mfma_f32_16x16x32_bf16 v[28:31], v[10:13], v[108:111], 0
    v_mfma_f32_16x16x32_bf16 v[32:35], v[10:13], v[112:115], 0
    v_mfma_f32_16x16x32_bf16 v[36:39], v[10:13], v[116:119], 0
    v_mfma_f32_16x16x32_bf16 v[40:43], v[10:13], v[120:123], 0
    v_mfma_f32_16x16x32_bf16 v[44:47], v[10:13], v[124:127], 0
    v_mfma_f32_16x16x32_bf16 v[48:51], v[10:13], v[128:131], 0
    v_mfma_f32_16x16x32_bf16 v[52:55], v[10:13], v[132:135], 0
    v_mfma_f32_16x16x32_bf16 v[56:59], v[10:13], v[136:139], 0
    v_mfma_f32_16x16x32_bf16 v[60:63], v[10:13], v[140:143], 0
    v_mfma_f32_16x16x32_bf16 v[64:67], v[10:13], v[144:147], 0
    v_add_f32 v28, v28, v29
    v_add_f32 v30, v30, v31
    v_add_f32 v28, v28, v30
    v_add_f32 v32, v32, v33
    v_add_f32 v34, v34, v35
    v_add_f32 v32, v32, v34
    v_add_f32 v36, v36, v37
    v_add_f32 v38, v38, v39
    v_add_f32 v36, v36, v38
    v_add_f32 v40, v40, v41
    v_add_f32 v42, v42, v43
    v_add_f32 v40, v40, v42
    v_add_f32 v44, v44, v45
    v_add_f32 v46, v46, v47
    v_add_f32 v44, v44, v46
    v_add_f32 v48, v48, v49
    v_add_f32 v50, v50, v51
    v_add_f32 v48, v48, v50
    v_add_f32 v52, v52, v53
    v_add_f32 v54, v54, v55
    v_add_f32 v52, v52, v54
    v_add_f32 v56, v56, v57
    v_add_f32 v58, v58, v59
    v_add_f32 v56, v56, v58
    v_add_f32 v60, v60, v61
    v_add_f32 v62, v62, v63
    v_add_f32 v60, v60, v62
    v_add_f32 v64, v64, v65
    v_add_f32 v66, v66, v67
    v_add_f32 v64, v64, v66
    v_cndmask_b32 v68, v28, v32, s[76:77]
    v_cndmask_b32 v69, v36, v40, s[76:77]
    v_cndmask_b32 v70, v44, v48, s[76:77]
    v_cndmask_b32 v71, v52, v56, s[76:77]
    v_cndmask_b32 v72, v60, v64, s[76:77]
    ds_write2st64_b32 v167, v68, v69 offset0:0 offset1:1
    ds_write2st64_b32 v167, v70, v71 offset0:2 offset1:3
    ds_write_b32 v167, v72 offset:1024
    s_waitcnt lgkmcnt(0)
    s_barrier
    ds_read2st64_b32 v[188:189], v166 offset0:0 offset1:5
    ds_read2st64_b32 v[190:191], v166 offset0:10 offset1:15
    ds_read2st64_b32 v[192:193], v168 offset0:0 offset1:5
    ds_read2st64_b32 v[194:195], v168 offset0:10 offset1:15
    s_waitcnt lgkmcnt(2)
    v_add_f32 v188, v188, v189
    v_add_f32 v190, v190, v191
    v_add_f32 v188, v188, v190
    buffer_store_dword v188, v165, s[36:39], s63 offen sc1
    s_cmp_eq_u32 s56, 0
    s_cbranch_scc0 L_s5skip_21
    s_waitcnt lgkmcnt(0)
    v_add_f32 v192, v192, v193
    v_add_f32 v194, v194, v195
    v_add_f32 v192, v192, v194
    buffer_store_dword v192, v165, s[36:39], s62 offen sc1
L_s5skip_21:
    s_branch L_done
L_B:
    s_sub_u32 s10, s58, 4
    s_and_b32 s67, s10, 1
    s_lshr_b32 s66, s10, 1
    s_lshl_b32 s68, s10, 5
    s_add_u32 s68, s68, s57
    s_and_b32 s11, s68, 63
    s_lshr_b32 s61, s68, 6
    s_add_u32 s13, s61, 1
    s_cmp_lt_u32 s11, 54
    s_cselect_b32 s13, s13, 3
    s_mul_i32 s61, s61, 10
    s_add_u32 s12, s11, s61
    s_sub_u32 s12, s12, 54
    s_mov_b32 s40, s6
    s_and_b32 s41, s7, 0xffff
    s_mov_b32 s42, 8388608
    s_mov_b32 s43, 0x00020000
    s_lshl_b32 s24, s66, 12
    s_lshl_b32 s62, s57, 7
    s_add_u32 s24, s24, s62
    s_lshl_b32 s62, s56, 5
    s_add_u32 s24, s24, s62
    s_lshl_b32 s24, s24, 10
    s_mul_i32 s25, s56, 33792
    s_add_u32 s25, s25, 0
    v_lshlrev_b32 v240, 4, v1
    s_mul_i32 s64, s67, 16384
    s_add_u32 s24, s24, s64
    s_mul_i32 s64, s67, 16896
    s_add_u32 s25, s25, s64
L_B_rows0:
L_B_rowsE:
    s_mov_b32 m0, s25
    s_add_u32 s25, s25, 1056
    buffer_load_dwordx4 v240, s[40:43], s24 offen lds
    s_add_u32 s24, s24, 1024
    s_mov_b32 m0, s25
    s_add_u32 s25, s25, 1056
    buffer_load_dwordx4 v240, s[40:43], s24 offen lds
    s_add_u32 s24, s24, 1024
    s_mov_b32 m0, s25
    s_add_u32 s25, s25, 1056
    buffer_load_dwordx4 v240, s[40:43], s24 offen lds
    s_add_u32 s24, s24, 1024
    s_mov_b32 m0, s25
    s_add_u32 s25, s25, 1056
    buffer_load_dwordx4 v240, s[40:43], s24 offen lds
    s_add_u32 s24, s24, 1024
    s_mov_b32 m0, s25
    s_add_u32 s25, s25, 1056
    buffer_load_dwordx4 v240, s[40:43], s24 offen lds
    s_add_u32 s24, s24, 1024
    s_mov_b32 m0, s25
    s_add_u32 s25, s25, 1056
    buffer_load_dwordx4 v240, s[40:43], s24 offen lds
    s_add_u32 s24, s24, 1024
    s_mov_b32 m0, s25
    s_add_u32 s25, s25, 1056
    buffer_load_dwordx4 v240, s[40:43], s24 offen lds
    s_add_u32 s24, s24, 1024
    s_mov_b32 m0, s25
    s_add_u32 s25, s25, 1056
    buffer_load_dwordx4 v240, s[40:43], s24 offen lds
    s_add_u32 s24, s24, 1024
    s_cmp_eq_u32 s56, 0
    s_cbranch_scc1 L_acw_22
    s_waitcnt vmcnt(8)
    v_readfirstlane_b32 s59, v202
    s_nop 3
    s_add_u32 s59, s59, 1
    s_mul_i32 s60, s59, 0x9e3779b1
    s_xor_b32 s60, s60, 0x5bd1e995
L_acw_22:
    s_barrier
    s_cmp_eq_u32 s56, 1
    s_cbranch_scc0 L_acp_23
    s_lshl_b32 s64, s57, 2
    s_add_u32 s64, s64, s10
    s_lshl_b32 s64, s64, 3
    s_add_u32 s64, s64, 917504
    v_mov_b32 v168, s59
    v_mov_b32 v169, s60
    v_mov_b32 v170, 0
    s_mov_b64 exec, 1
    buffer_store_dwordx2 v[168:169], v170, s[36:39], s64 offen sc1
    s_mov_b64 exec, -1
L_acp_23:
    v_lshlrev_b32 v165, 3, v1
    s_lshl_b32 s16, s67, 9
    s_add_u32 s14, s16, 925696
    s_add_u32 s16, s16, 917504
    s_mov_b32 m0, s25
    s_add_u32 s25, s25, 1056
    buffer_load_dwordx4 v240, s[40:43], s24 offen lds
    s_add_u32 s24, s24, 1024
    s_waitcnt vmcnt(7)
    s_mov_b32 m0, s25
    s_add_u32 s25, s25, 1056
    buffer_load_dwordx4 v240, s[40:43], s24 offen lds
    s_add_u32 s24, s24, 1024
    s_waitcnt vmcnt(7)
    s_mov_b32 m0, s25
    s_add_u32 s25, s25, 1056
    buffer_load_dwordx4 v240, s[40:43], s24 offen lds
    s_add_u32 s24, s24, 1024
    s_waitcnt vmcnt(7)
    s_mov_b32 m0, s25
    s_add_u32 s25, s25, 1056
    buffer_load_dwordx4 v240, s[40:43], s24 offen lds
    s_add_u32 s24, s24, 1024
    s_waitcnt vmcnt(7)
    s_mov_b32 m0, s25
    s_add_u32 s25, s25, 1056
    buffer_load_dwordx4 v240, s[40:43], s24 offen lds
    s_add_u32 s24, s24, 1024
    s_waitcnt vmcnt(7)
    s_mov_b32 m0, s25
    s_add_u32 s25, s25, 1056
    buffer_load_dwordx4 v240, s[40:43], s24 offen lds
    s_add_u32 s24, s24, 1024
    s_waitcnt vmcnt(7)
    s_mov_b32 m0, s25
    s_add_u32 s25, s25, 1056
    buffer_load_dwordx4 v240, s[40:43], s24 offen lds
    s_add_u32 s24, s24, 1024
    s_waitcnt vmcnt(7)
    s_mov_b32 m0, s25
    s_add_u32 s25, s25, 1056
    buffer_load_dwordx4 v240, s[40:43], s24 offen lds
    s_add_u32 s24, s24, 1024
    s_mul_i32 s64, s67, 32768
    s_sub_u32 s24, s24, s64
    s_mul_i32 s64, s67, 33792
    s_sub_u32 s25, s25, s64
    s_waitcnt vmcnt(7)
    s_mov_b32 m0, s25
    s_add_u32 s25, s25, 1056
    buffer_load_dwordx4 v240, s[40:43], s24 offen lds
    s_add_u32 s24, s24, 1024
    s_waitcnt vmcnt(7)
    s_mov_b32 m0, s25
    s_add_u32 s25, s25, 1056
    buffer_load_dwordx4 v240, s[40:43], s24 offen lds
    s_add_u32 s24, s24, 1024
    s_waitcnt vmcnt(7)
    s_mov_b32 m0, s25
    s_add_u32 s25, s25, 1056
    buffer_load_dwordx4 v240, s[40:43], s24 offen lds
    s_add_u32 s24, s24, 1024
    s_waitcnt vmcnt(7)
    s_mov_b32 m0, s25
    s_add_u32 s25, s25, 1056
    buffer_load_dwordx4 v240, s[40:43], s24 offen lds
    s_add_u32 s24, s24, 1024
    s_waitcnt vmcnt(7)
    s_mov_b32 m0, s25
    s_add_u32 s25, s25, 1056
    buffer_load_dwordx4 v240, s[40:43], s24 offen lds
    s_add_u32 s24, s24, 1024
    s_waitcnt vmcnt(7)
    s_mov_b32 m0, s25
    s_add_u32 s25, s25, 1056
    buffer_load_dwordx4 v240, s[40:43], s24 offen lds
    s_add_u32 s24, s24, 1024
    s_waitcnt vmcnt(7)
    s_mov_b32 m0, s25
    s_add_u32 s25, s25, 1056
    buffer_load_dwordx4 v240, s[40:43], s24 offen lds
    s_add_u32 s24, s24, 1024
    s_waitcnt vmcnt(7)
    s_mov_b32 m0, s25
    s_add_u32 s25, s25, 1056
    buffer_load_dwordx4 v240, s[40:43], s24 offen lds
    s_add_u32 s24, s24, 1024
    s_waitcnt vmcnt(7)
    s_mov_b32 m0, s25
    s_add_u32 s25, s25, 1056
    buffer_load_dwordx4 v240, s[40:43], s24 offen lds
    s_add_u32 s24, s24, 1024
    s_waitcnt vmcnt(7)
    s_mov_b32 m0, s25
    s_add_u32 s25, s25, 1056
    buffer_load_dwordx4 v240, s[40:43], s24 offen lds
    s_add_u32 s24, s24, 1024
    s_waitcnt vmcnt(7)
    s_mov_b32 m0, s25
    s_add_u32 s25, s25, 1056
    buffer_load_dwordx4 v240, s[40:43], s24 offen lds
    s_add_u32 s24, s24, 1024
    s_waitcnt vmcnt(7)
    s_mov_b32 m0, s25
    s_add_u32 s25, s25, 1056
    buffer_load_dwordx4 v240, s[40:43], s24 offen lds
    s_add_u32 s24, s24, 1024
    buffer_load_dwordx2 v[74:75], v165, s[36:39], s14 offen sc1
    buffer_load_dwordx2 v[190:191], v165, s[36:39], s16 offen sc1
    s_waitcnt vmcnt(9)
    s_mov_b32 m0, s25
    s_add_u32 s25, s25, 1056
    buffer_load_dwordx4 v240, s[40:43], s24 offen lds
    s_add_u32 s24, s24, 1024
    s_waitcnt vmcnt(9)
    s_mov_b32 m0, s25
    s_add_u32 s25, s25, 1056
    buffer_load_dwordx4 v240, s[40:43], s24 offen lds
    s_add_u32 s24, s24, 1024
    s_waitcnt vmcnt(9)
    s_mov_b32 m0, s25
    s_add_u32 s25, s25, 1056
    buffer_load_dwordx4 v240, s[40:43], s24 offen lds
    s_add_u32 s24, s24, 1024
    s_waitcnt vmcnt(9)
    s_mov_b32 m0, s25
    s_add_u32 s25, s25, 1056
    buffer_load_dwordx4 v240, s[40:43], s24 offen lds
    s_add_u32 s24, s24, 1024
    s_mov_b32 s52, s22
    s_and_b32 s53, s23, 0xffff
    s_mov_b32 s54, 2560
    s_mov_b32 s55, 0x00020000
    s_mul_i32 s17, s56, 10240
    s_add_u32 s17, s17, 0
    s_mov_b32 s44, s20
    s_and_b32 s45, s21, 0xffff
    s_mov_b32 s46, 2211840
    s_mov_b32 s47, 0x00020000
    s_cmp_eq_u32 s13, 2
    s_cselect_b32 s46, 2211840, 0
    v_lshlrev_b32 v194, 4, v1
    s_mul_i32 s22, s11, 40960
    s_mul_i32 s61, s56, 10240
    s_add_u32 s22, s22, s61
    s_mov_b32 s23, 1024
    s_lshl_b32 s61, s56, 5
    v_add_u32 v166, s61, v2
    v_mul_u32_u24 v166, 1056, v166
    v_lshl_add_u32 v166, v3, 8, v166
    v_and_b32 v167, 1, v3
    v_lshlrev_b32 v167, 4, v167
    s_mul_i32 s61, s67, 16896
    s_sub_u32 s62, 16896, s61
    v_add_u32 v150, v166, v167
    v_sub_u32 v151, v166, v167
    v_add_u32 v236, s62, v150
    v_add_u32 v237, s62, v151
    v_add_u32 v150, s61, v150
    v_add_u32 v151, s61, v151
    v_mul_u32_u24 v166, 1056, v2
    v_lshl_add_u32 v166, v3, 8, v166
    v_add_u32 v166, 135168, v166
    v_add_u32 v152, v166, v167
    v_sub_u32 v153, v166, v167
    v_lshrrev_b32 v166, 2, v2
    v_lshl_add_u32 v166, v3, 2, v166
    v_mul_u32_u24 v166, 1056, v166
    v_and_b32 v167, 3, v2
    v_lshl_add_u32 v166, v167, 3, v166
    s_lshl_b32 s61, s56, 8
    v_add_u32 v166, s61, v166
    s_mul_i32 s61, s67, 16896
    s_sub_u32 s62, 16896, s61
    v_add_u32 v154, s61, v166
    v_add_u32 v155, 67584, v154
    v_add_u32 v238, s62, v166
    v_add_u32 v239, 67584, v238
    v_lshlrev_b32 v156, 4, v0
    s_mul_i32 s61, s56, 1056
    s_add_u32 s61, s61, 135168
    v_lshlrev_b32 v166, 4, v1
    v_add_u32 v157, s61, v166
    v_lshlrev_b32 v167, 2, v1
    s_lshl_b32 s61, s56, 8
    s_add_u32 s61, s61, 154624
    v_add_u32 v158, s61, v167
    v_add_u32 v159, 154624, v167
    s_lshl_b32 s61, s56, 10
    s_add_u32 s61, s61, 155648
    v_add_u32 v160, s61, v166
    v_add_u32 v161, 155648, v166
    s_mul_i32 s61, s56, 4352
    s_add_u32 s61, s61, 98304
    v_mul_u32_u24 v166, 272, v2
    v_lshl_add_u32 v166, v3, 4, v166
    v_add_u32 v162, s61, v166
    v_lshrrev_b32 v166, 3, v1
    v_mul_u32_u24 v166, 272, v166
    v_and_b32 v167, 7, v1
    v_lshl_add_u32 v166, v167, 4, v166
    v_add_u32 v192, s61, v166
    v_lshrrev_b32 v166, 3, v1
    v_lshlrev_b32 v166, 16, v166
    v_lshl_add_u32 v193, v167, 4, v166
    v_lshlrev_b32 v163, 9, v2
    v_mov_b32 v186, 0x3f803f80
    v_mov_b32 v187, 0x3f803f80
    v_mov_b32 v188, 0x3f803f80
    v_mov_b32 v189, 0x3f803f80
    s_waitcnt vmcnt(18)
    ds_read_b128 a[0:3], v150 offset:0
    ds_read_b128 a[4:7], v151 offset:16
    ds_read_b128 a[8:11], v150 offset:32
    ds_read_b128 a[12:15], v151 offset:48
    ds_read_b128 a[16:19], v150 offset:64
    ds_read_b128 a[20:23], v151 offset:80
    ds_read_b128 a[24:27], v150 offset:96
    ds_read_b128 a[28:31], v151 offset:112
    ds_read_b128 a[32:35], v150 offset:128
    ds_read_b128 a[36:39], v151 offset:144
    ds_read_b128 a[40:43], v150 offset:160
    ds_read_b128 a[44:47], v151 offset:176
    ds_read_b128 a[48:51], v150 offset:192
    ds_read_b128 a[52:55], v151 offset:208
    ds_read_b128 a[56:59], v150 offset:224
    ds_read_b128 a[60:63], v151 offset:240
    s_barrier
    ds_read_b64_tr_b16 a[128:129], v154 offset:0
    ds_read_b64_tr_b16 a[132:133], v154 offset:33792
    ds_read_b64_tr_b16 a[136:137], v155 offset:0
    ds_read_b64_tr_b16 a[140:141], v155 offset:33792
    ds_read_b64_tr_b16 a[144:145], v154 offset:32
    ds_read_b64_tr_b16 a[148:149], v154 offset:33824
    ds_read_b64_tr_b16 a[152:153], v155 offset:32
    ds_read_b64_tr_b16 a[156:157], v155 offset:33824
    ds_read_b64_tr_b16 a[160:161], v154 offset:64
    ds_read_b64_tr_b16 a[164:165], v154 offset:33856
    ds_read_b64_tr_b16 a[168:169], v155 offset:64
    ds_read_b64_tr_b16 a[172:173], v155 offset:33856
    ds_read_b64_tr_b16 a[176:177], v154 offset:96
    ds_read_b64_tr_b16 a[180:181], v154 offset:33888
    ds_read_b64_tr_b16 a[184:185], v155 offset:96
    ds_read_b64_tr_b16 a[188:189], v155 offset:33888
    ds_read_b64_tr_b16 a[192:193], v154 offset:128
    ds_read_b64_tr_b16 a[196:197], v154 offset:33920
    ds_read_b64_tr_b16 a[200:201], v155 offset:128
    ds_read_b64_tr_b16 a[204:205], v155 offset:33920
    ds_read_b64_tr_b16 a[208:209], v154 offset:160
    ds_read_b64_tr_b16 a[212:213], v154 offset:33952
    ds_read_b64_tr_b16 a[216:217], v155 offset:160
    ds_read_b64_tr_b16 a[220:221], v155 offset:33952
    ds_read_b64_tr_b16 a[224:225], v154 offset:192
    ds_read_b64_tr_b16 a[228:229], v154 offset:33984
    ds_read_b64_tr_b16 a[232:233], v155 offset:192
    ds_read_b64_tr_b16 a[236:237], v155 offset:33984
    ds_read_b64_tr_b16 a[240:241], v154 offset:224
    ds_read_b64_tr_b16 a[244:245], v154 offset:34016
    ds_read_b64_tr_b16 a[248:249], v155 offset:224
    ds_read_b64_tr_b16 a[252:253], v155 offset:34016
    s_mov_b32 s71, 0
    s_mov_b64 s[72:73], exec
    s_waitcnt vmcnt(4)
    s_branch L_fl_24_c
L_fl_24:
    s_waitcnt vmcnt(0)
L_fl_24_c:
    v_xor_b32 v5, s59, v74
    v_xor_b32 v6, s60, v75
    v_or_b32 v4, v5, v6
    v_xor_b32 v5, s59, v190
    v_xor_b32 v6, s60, v191
    v_or3_b32 v4, v4, v5, v6
    v_cmp_ne_u32 vcc, 0, v4
    s_and_b64 exec, exec, vcc
    s_cbranch_execz L_fld_25
    s_add_u32 s71, s71, 1
    s_cmp_ge_u32 s71, 100000
    s_cbranch_scc1 L_fld_25
    buffer_load_dwordx2 v[74:75], v165, s[36:39], s14 offen sc1
    buffer_load_dwordx2 v[190:191], v165, s[36:39], s16 offen sc1
    s_branch L_fl_24
L_fld_25:
    s_mov_b64 exec, s[72:73]
    s_lshl_b32 s61, s66, 15
    s_lshl_b32 s62, s67, 14
    s_add_u32 s61, s61, s62
    s_add_u32 s61, s61, 266240
    s_add_u32 s62, s61, 4096
    s_add_u32 s63, s61, 8192
    s_add_u32 s64, s61, 12288
    buffer_load_dwordx4 v[74:77], v156, s[36:39], s61 offen sc1
    buffer_load_dwordx4 v[78:81], v156, s[36:39], s62 offen sc1
    buffer_load_dwordx4 v[82:85], v156, s[36:39], s63 offen sc1
    buffer_load_dwordx4 v[86:89], v156, s[36:39], s64 offen sc1
    s_waitcnt vmcnt(4)
    ds_read_b128 a[64:67], v236 offset:0
    ds_read_b128 a[68:71], v237 offset:16
    ds_read_b128 a[72:75], v236 offset:32
    ds_read_b128 a[76:79], v237 offset:48
    ds_read_b128 a[80:83], v236 offset:64
    ds_read_b128 a[84:87], v237 offset:80
    ds_read_b128 a[88:91], v236 offset:96
    ds_read_b128 a[92:95], v237 offset:112
    ds_read_b128 a[96:99], v236 offset:128
    ds_read_b128 a[100:103], v237 offset:144
    ds_read_b128 a[104:107], v236 offset:160
    ds_read_b128 a[108:111], v237 offset:176
    ds_read_b128 a[112:115], v236 offset:192
    ds_read_b128 a[116:119], v237 offset:208
    ds_read_b128 a[120:123], v236 offset:224
    ds_read_b128 a[124:127], v237 offset:240
    s_mov_b32 s71, 0
    s_mov_b64 s[72:73], exec
L_qa_26:
    s_waitcnt vmcnt(0)
    v_max3_u32 v4, v74, v75, v76
    v_max3_u32 v4, v4, v77, v78
    v_max3_u32 v4, v4, v79, v80
    v_max3_u32 v4, v4, v81, v82
    v_max3_u32 v4, v4, v83, v84
    v_max3_u32 v4, v4, v85, v86
    v_max3_u32 v4, v4, v87, v88
    v_max_u32 v4, v4, v89
    v_cmp_eq_u32 vcc, -1, v4
    s_and_b64 exec, exec, vcc
    s_cbranch_execz L_qad_27
    s_add_u32 s71, s71, 1
    s_cmp_ge_u32 s71, 100000
    s_cbranch_scc1 L_qad_27
    buffer_load_dwordx4 v[74:77], v156, s[36:39], s61 offen sc1
    buffer_load_dwordx4 v[78:81], v156, s[36:39], s62 offen sc1
    buffer_load_dwordx4 v[82:85], v156, s[36:39], s63 offen sc1
    buffer_load_dwordx4 v[86:89], v156, s[36:39], s64 offen sc1
    s_branch L_qa_26
L_qad_27:
    s_mov_b64 exec, s[72:73]
    ds_write_b128 v157, v[74:77] offset:0
    ds_write_b128 v157, v[78:81] offset:4224
    ds_write_b128 v157, v[82:85] offset:8448
    ds_write_b128 v157, v[86:89] offset:12672
    s_waitcnt lgkmcnt(0)
    s_barrier
    ds_read_b128 v[10:13], v152 offset:0
    ds_read_b128 v[14:17], v153 offset:16
    ds_read_b128 v[18:21], v152 offset:32
    ds_read_b128 v[22:25], v153 offset:48
    ds_read_b128 v[26:29], v152 offset:64
    ds_read_b128 v[30:33], v153 offset:80
    ds_read_b128 v[34:37], v152 offset:96
    ds_read_b128 v[38:41], v153 offset:112
    ds_read_b128 v[42:45], v152 offset:128
    ds_read_b128 v[46:49], v153 offset:144
    ds_read_b128 v[50:53], v152 offset:160
    ds_read_b128 v[54:57], v153 offset:176
    ds_read_b128 v[58:61], v152 offset:192
    ds_read_b128 v[62:65], v153 offset:208
    ds_read_b128 v[66:69], v152 offset:224
    ds_read_b128 v[70:73], v153 offset:240
    s_waitcnt lgkmcnt(15)
    v_mfma_f32_16x16x32_bf16 v[122:125], a[0:3], v[10:13], 0
    v_mfma_f32_16x16x32_bf16 v[126:129], a[64:67], v[10:13], 0
    s_waitcnt lgkmcnt(14)
    v_mfma_f32_16x16x32_bf16 v[122:125], a[4:7], v[14:17], v[122:125]
    v_mfma_f32_16x16x32_bf16 v[126:129], a[68:71], v[14:17], v[126:129]
    buffer_load_dwordx4 v[196:199], v194, s[44:47], s22 offen
    s_add_u32 s22, s22, s23
    s_waitcnt lgkmcnt(13)
    v_mfma_f32_16x16x32_bf16 v[122:125], a[8:11], v[18:21], v[122:125]
    v_mfma_f32_16x16x32_bf16 v[126:129], a[72:75], v[18:21], v[126:129]
    s_waitcnt lgkmcnt(12)
    v_mfma_f32_16x16x32_bf16 v[122:125], a[12:15], v[22:25], v[122:125]
    v_mfma_f32_16x16x32_bf16 v[126:129], a[76:79], v[22:25], v[126:129]
    buffer_load_dwordx4 v[200:203], v194, s[44:47], s22 offen
    s_add_u32 s22, s22, s23
    s_waitcnt lgkmcnt(11)
    v_mfma_f32_16x16x32_bf16 v[122:125], a[16:19], v[26:29], v[122:125]
    v_mfma_f32_16x16x32_bf16 v[126:129], a[80:83], v[26:29], v[126:129]
    s_waitcnt lgkmcnt(10)
    v_mfma_f32_16x16x32_bf16 v[122:125], a[20:23], v[30:33], v[122:125]
    v_mfma_f32_16x16x32_bf16 v[126:129], a[84:87], v[30:33], v[126:129]
    buffer_load_dwordx4 v[204:207], v194, s[44:47], s22 offen
    s_add_u32 s22, s22, s23
    s_waitcnt lgkmcnt(9)
    v_mfma_f32_16x16x32_bf16 v[122:125], a[24:27], v[34:37], v[122:125]
    v_mfma_f32_16x16x32_bf16 v[126:129], a[88:91], v[34:37], v[126:129]
    s_waitcnt lgkmcnt(8)
    v_mfma_f32_16x16x32_bf16 v[122:125], a[28:31], v[38:41], v[122:125]
    v_mfma_f32_16x16x32_bf16 v[126:129], a[92:95], v[38:41], v[126:129]
    buffer_load_dwordx4 v[208:211], v194, s[44:47], s22 offen
    s_add_u32 s22, s22, s23
    s_waitcnt lgkmcnt(0)
    v_mfma_f32_16x16x32_bf16 v[122:125], a[32:35], v[42:45], v[122:125]
    v_mfma_f32_16x16x32_bf16 v[126:129], a[96:99], v[42:45], v[126:129]
    ds_read_b64_tr_b16 a[130:131], v238 offset:0
    ds_read_b64_tr_b16 a[134:135], v238 offset:33792
    ds_read_b64_tr_b16 a[138:139], v239 offset:0
    ds_read_b64_tr_b16 a[142:143], v239 offset:33792
    v_mfma_f32_16x16x32_bf16 v[122:125], a[36:39], v[46:49], v[122:125]
    v_mfma_f32_16x16x32_bf16 v[126:129], a[100:103], v[46:49], v[126:129]
    ds_read_b64_tr_b16 a[146:147], v238 offset:32
    ds_read_b64_tr_b16 a[150:151], v238 offset:33824
    ds_read_b64_tr_b16 a[154:155], v239 offset:32
    ds_read_b64_tr_b16 a[158:159], v239 offset:33824
    buffer_load_dwordx4 v[212:215], v194, s[44:47], s22 offen
    s_add_u32 s22, s22, s23
    v_mfma_f32_16x16x32_bf16 v[122:125], a[40:43], v[50:53], v[122:125]
    v_mfma_f32_16x16x32_bf16 v[126:129], a[104:107], v[50:53], v[126:129]
    ds_read_b64_tr_b16 a[162:163], v238 offset:64
    ds_read_b64_tr_b16 a[166:167], v238 offset:33856
    ds_read_b64_tr_b16 a[170:171], v239 offset:64
    ds_read_b64_tr_b16 a[174:175], v239 offset:33856
    v_mfma_f32_16x16x32_bf16 v[122:125], a[44:47], v[54:57], v[122:125]
    v_mfma_f32_16x16x32_bf16 v[126:129], a[108:111], v[54:57], v[126:129]
    ds_read_b64_tr_b16 a[178:179], v238 offset:96
    ds_read_b64_tr_b16 a[182:183], v238 offset:33888
    ds_read_b64_tr_b16 a[186:187], v239 offset:96
    ds_read_b64_tr_b16 a[190:191], v239 offset:33888
    buffer_load_dwordx4 v[216:219], v194, s[44:47], s22 offen
    s_add_u32 s22, s22, s23
    v_mfma_f32_16x16x32_bf16 v[122:125], a[48:51], v[58:61], v[122:125]
    v_mfma_f32_16x16x32_bf16 v[126:129], a[112:115], v[58:61], v[126:129]
    ds_read_b64_tr_b16 a[194:195], v238 offset:128
    ds_read_b64_tr_b16 a[198:199], v238 offset:33920
    ds_read_b64_tr_b16 a[202:203], v239 offset:128
    ds_read_b64_tr_b16 a[206:207], v239 offset:33920
    v_mfma_f32_16x16x32_bf16 v[122:125], a[52:55], v[62:65], v[122:125]
    v_mfma_f32_16x16x32_bf16 v[126:129], a[116:119], v[62:65], v[126:129]
    ds_read_b64_tr_b16 a[210:211], v238 offset:160
    ds_read_b64_tr_b16 a[214:215], v238 offset:33952
    ds_read_b64_tr_b16 a[218:219], v239 offset:160
    ds_read_b64_tr_b16 a[222:223], v239 offset:33952
    v_mfma_f32_16x16x32_bf16 v[122:125], a[56:59], v[66:69], v[122:125]
    v_mfma_f32_16x16x32_bf16 v[126:129], a[120:123], v[66:69], v[126:129]
    ds_read_b64_tr_b16 a[226:227], v238 offset:192
    ds_read_b64_tr_b16 a[230:231], v238 offset:33984
    ds_read_b64_tr_b16 a[234:235], v239 offset:192
    ds_read_b64_tr_b16 a[238:239], v239 offset:33984
    v_mfma_f32_16x16x32_bf16 v[122:125], a[60:63], v[70:73], v[122:125]
    v_mfma_f32_16x16x32_bf16 v[126:129], a[124:127], v[70:73], v[126:129]
    ds_read_b64_tr_b16 a[242:243], v238 offset:224
    ds_read_b64_tr_b16 a[246:247], v238 offset:34016
    ds_read_b64_tr_b16 a[250:251], v239 offset:224
    ds_read_b64_tr_b16 a[254:255], v239 offset:34016
    s_nop 7
    v_max3_f32 v166, v122, v123, v124
    v_max3_f32 v167, v125, v126, v127
    v_max3_f32 v166, v166, v128, v129
    v_max_f32 v166, v166, v167
    v_mov_b32 v167, v166
    s_nop 1
    v_permlane16_swap_b32 v166, v167
    s_nop 0
    v_max_f32 v166, v166, v167
    v_mov_b32 v167, v166
    s_nop 1
    v_permlane32_swap_b32 v166, v167
    s_nop 0
    v_max_f32 v166, v166, v167
    ds_write_b32 v158, v166
    s_waitcnt lgkmcnt(0)
    s_barrier
    ds_read2st64_b32 v[166:167], v159 offset0:0 offset1:1
    ds_read2st64_b32 v[168:169], v159 offset0:2 offset1:3
    s_waitcnt lgkmcnt(0)
    v_max3_f32 v166, v166, v167, v168
    v_max_f32 v170, v166, v169
    v_sub_f32 v122, v122, v170
    v_sub_f32 v123, v123, v170
    v_sub_f32 v124, v124, v170
    v_sub_f32 v125, v125, v170
    v_sub_f32 v126, v126, v170
    v_sub_f32 v127, v127, v170
    v_sub_f32 v128, v128, v170
    v_sub_f32 v129, v129, v170
    v_exp_f32 v122, v122
    v_exp_f32 v123, v123
    v_exp_f32 v124, v124
    v_exp_f32 v125, v125
    v_exp_f32 v126, v126
    v_exp_f32 v127, v127
    v_exp_f32 v128, v128
    v_exp_f32 v129, v129
    s_nop 0
    v_cvt_pk_bf16_f32 v166, v122, v123
    v_cvt_pk_bf16_f32 v167, v124, v125
    v_cvt_pk_bf16_f32 v168, v126, v127
    v_cvt_pk_bf16_f32 v169, v128, v129
    ds_write_b128 v160, v[166:169]
    s_waitcnt lgkmcnt(0)
    s_barrier
    ds_read_b128 v[130:133], v161 offset:0
    ds_read_b128 v[134:137], v161 offset:1024
    ds_read_b128 v[138:141], v161 offset:2048
    ds_read_b128 v[142:145], v161 offset:3072
    s_lshl_b32 s61, s67, 20
    s_lshl_b32 s62, s56, 14
    s_add_u32 s61, s61, s62
    s_lshl_b32 s62, s66, 5
    s_add_u32 s62, s62, s57
    s_lshl_b32 s63, s62, 8
    s_add_u32 s61, s61, s63
    s_add_u32 s61, s61, 1048576
    s_lshl_b32 s62, s62, 3
    s_lshl_b32 s63, s67, 13
    s_add_u32 s62, s62, s63
    s_add_u32 s62, s62, 331776
    s_add_u32 s63, s61, 524288
    s_cmp_eq_u32 s56, 0
    s_cselect_b32 s62, s62, 0x7f000000
    s_waitcnt lgkmcnt(3)
    v_mfma_f32_16x16x32_bf16 v[146:149], v[186:189], v[130:133], 0
    s_waitcnt lgkmcnt(2)
    v_mfma_f32_16x16x32_bf16 v[146:149], v[186:189], v[134:137], v[146:149]
    s_waitcnt lgkmcnt(1)
    v_mfma_f32_16x16x32_bf16 v[146:149], v[186:189], v[138:141], v[146:149]
    s_waitcnt lgkmcnt(0)
    v_mfma_f32_16x16x32_bf16 v[146:149], v[186:189], v[142:145], v[146:149]
    v_mfma_f32_16x16x32_bf16 v[90:93], a[128:131], v[130:133], 0
    v_mfma_f32_16x16x32_bf16 v[94:97], a[144:147], v[130:133], 0
    v_mfma_f32_16x16x32_bf16 v[90:93], a[132:135], v[134:137], v[90:93]
    v_mfma_f32_16x16x32_bf16 v[94:97], a[148:151], v[134:137], v[94:97]
    v_mfma_f32_16x16x32_bf16 v[90:93], a[136:139], v[138:141], v[90:93]
    v_mfma_f32_16x16x32_bf16 v[94:97], a[152:155], v[138:141], v[94:97]
    v_mfma_f32_16x16x32_bf16 v[90:93], a[140:143], v[142:145], v[90:93]
    v_mfma_f32_16x16x32_bf16 v[94:97], a[156:159], v[142:145], v[94:97]
    v_mfma_f32_16x16x32_bf16 v[98:101], a[160:163], v[130:133], 0
    v_mov_b32 v171, v146
    v_mfma_f32_16x16x32_bf16 v[102:105], a[176:179], v[130:133], 0
    s_mov_b64 exec, 0xffff
    buffer_store_dwordx2 v[170:171], v163, s[36:39], s62 offen sc1
    s_mov_b64 exec, -1
    s_nop 3
    v_mfma_f32_16x16x32_bf16 v[98:101], a[164:167], v[134:137], v[98:101]
    v_mfma_f32_16x16x32_bf16 v[102:105], a[180:183], v[134:137], v[102:105]
    v_mfma_f32_16x16x32_bf16 v[98:101], a[168:171], v[138:141], v[98:101]
    v_mfma_f32_16x16x32_bf16 v[102:105], a[184:187], v[138:141], v[102:105]
    v_mfma_f32_16x16x32_bf16 v[98:101], a[172:175], v[142:145], v[98:101]
    v_mfma_f32_16x16x32_bf16 v[102:105], a[188:191], v[142:145], v[102:105]
    v_mfma_f32_16x16x32_bf16 v[106:109], a[192:195], v[130:133], 0
    v_cvt_pk_bf16_f32 v10, v90, v91
    v_mfma_f32_16x16x32_bf16 v[110:113], a[208:211], v[130:133], 0
    v_cvt_pk_bf16_f32 v11, v92, v93
    v_mfma_f32_16x16x32_bf16 v[106:109], a[196:199], v[134:137], v[106:109]
    v_cvt_pk_bf16_f32 v12, v94, v95
    v_mfma_f32_16x16x32_bf16 v[110:113], a[212:215], v[134:137], v[110:113]
    v_cvt_pk_bf16_f32 v13, v96, v97
    v_mfma_f32_16x16x32_bf16 v[106:109], a[200:203], v[138:141], v[106:109]
    ds_write_b128 v162, v[10:13] offset:0
    v_mfma_f32_16x16x32_bf16 v[110:113], a[216:219], v[138:141], v[110:113]
    v_mfma_f32_16x16x32_bf16 v[106:109], a[204:207], v[142:145], v[106:109]
    v_mfma_f32_16x16x32_bf16 v[110:113], a[220:223], v[142:145], v[110:113]
    v_mfma_f32_16x16x32_bf16 v[114:117], a[224:227], v[130:133], 0
    v_cvt_pk_bf16_f32 v14, v98, v99
    v_mfma_f32_16x16x32_bf16 v[118:121], a[240:243], v[130:133], 0
    v_cvt_pk_bf16_f32 v15, v100, v101
    v_mfma_f32_16x16x32_bf16 v[114:117], a[228:231], v[134:137], v[114:117]
    v_cvt_pk_bf16_f32 v16, v102, v103
    v_mfma_f32_16x16x32_bf16 v[118:121], a[244:247], v[134:137], v[118:121]
    v_cvt_pk_bf16_f32 v17, v104, v105
    v_mfma_f32_16x16x32_bf16 v[114:117], a[232:235], v[138:141], v[114:117]
    ds_write_b128 v162, v[14:17] offset:64
    v_mfma_f32_16x16x32_bf16 v[118:121], a[248:251], v[138:141], v[118:121]
    v_mfma_f32_16x16x32_bf16 v[114:117], a[236:239], v[142:145], v[114:117]
    v_mfma_f32_16x16x32_bf16 v[118:121], a[252:255], v[142:145], v[118:121]
    s_waitcnt lgkmcnt(0)
    ds_read_b128 v[26:29], v192 offset:0
    ds_read_b128 v[30:33], v192 offset:2176
    v_cvt_pk_bf16_f32 v18, v106, v107
    v_cvt_pk_bf16_f32 v19, v108, v109
    v_cvt_pk_bf16_f32 v20, v110, v111
    v_cvt_pk_bf16_f32 v21, v112, v113
    ds_write_b128 v162, v[18:21] offset:128
    s_nop 0
    v_cvt_pk_bf16_f32 v22, v114, v115
    v_cvt_pk_bf16_f32 v23, v116, v117
    v_cvt_pk_bf16_f32 v24, v118, v119
    v_cvt_pk_bf16_f32 v25, v120, v121
    ds_write_b128 v162, v[22:25] offset:192
    s_waitcnt lgkmcnt(3)
    buffer_store_dwordx4 v[26:29], v193, s[36:39], s61 offen offset:0 sc1
    s_waitcnt lgkmcnt(2)
    buffer_store_dwordx4 v[30:33], v193, s[36:39], s63 offen offset:0 sc1
    s_waitcnt lgkmcnt(0)
    ds_read_b128 v[34:37], v192 offset:128
    ds_read_b128 v[38:41], v192 offset:2304
    s_waitcnt lgkmcnt(1)
    buffer_store_dwordx4 v[34:37], v193, s[36:39], s61 offen offset:128 sc1
    s_waitcnt lgkmcnt(0)
    buffer_store_dwordx4 v[38:41], v193, s[36:39], s63 offen offset:128 sc1
    buffer_load_dwordx4 v[220:223], v194, s[44:47], s22 offen
    s_add_u32 s22, s22, s23
    buffer_load_dwordx4 v[224:227], v194, s[44:47], s22 offen
    s_add_u32 s22, s22, s23
    buffer_load_dwordx4 v[228:231], v194, s[44:47], s22 offen
    s_add_u32 s22, s22, s23
    buffer_load_dwordx4 v[232:235], v194, s[44:47], s22 offen
L_B_r2:
    s_cmp_eq_u32 s13, 2
    s_cbranch_scc0 L_B_r3
    v_lshrrev_b32 v166, 2, v2
    v_lshl_add_u32 v166, v3, 2, v166
    v_and_b32 v167, 3, v2
    v_mul_u32_u24 v168, 1312, v166
    v_lshl_add_u32 v168, v167, 3, v168
    s_mul_i32 s61, s56, 320
    s_add_u32 s61, s61, 0
    v_add_u32 v178, s61, v168
    v_lshrrev_b32 v168, 5, v1
    v_lshlrev_b32 v168, 10, v168
    v_and_b32 v169, 31, v1
    v_lshl_add_u32 v182, v169, 4, v168
    s_lshr_b32 s64, s11, 1
    s_lshl_b32 s64, s64, 12
    s_and_b32 s65, s11, 1
    s_lshl_b32 s65, s65, 9
    s_add_u32 s64, s64, s65
    s_add_u32 s64, s64, 3145728
    v_bfe_u32 v168, v1, 2, 2
    v_lshlrev_b32 v168, 3, v168
    v_bfe_u32 v169, v1, 4, 1
    v_lshl_add_u32 v168, v169, 2, v168
    v_and_b32 v169, 3, v1
    v_add_u32 v168, v168, v169
    v_lshrrev_b32 v169, 5, v1
    v_lshl_add_u32 v168, v169, 5, v168
    v_lshlrev_b32 v168, 1, v168
    s_lshl_b32 s65, s56, 7
    s_add_u32 s65, s65, 81920
    v_add_u32 v179, s65, v168
    v_and_b32 v168, 1, v1
    v_lshlrev_b32 v168, 6, v168
    v_lshl_add_u32 v168, v3, 4, v168
    v_add_u32 v180, s65, v168
    v_lshlrev_b32 v183, 3, v1
    s_mul_i32 s63, s11, 5120
    s_mul_i32 s62, s56, 1280
    s_add_u32 s63, s63, s62
    s_add_u32 s63, s63, 577536
    s_mov_b32 s74, 0xffff0000
    s_mov_b32 s75, 0xffff0000
    s_mov_b32 s76, 0
    s_mov_b32 s77, -1
    buffer_load_dwordx4 v[152:155], v182, s[36:39], s64 offen sc1
    buffer_load_dwordx4 v[156:159], v182, s[36:39], s64 offen offset:2048 sc1
    s_mul_i32 s65, s56, 10496
    s_add_u32 s65, s65, 0
    s_movk_i32 s62, 205
    v_add_u32 v174, 0, v1
    v_mul_u32_u24 v175, s62, v174
    v_lshrrev_b32 v175, 14, v175
    v_lshlrev_b32 v175, 5, v175
    v_lshl_add_u32 v175, v174, 4, v175
    v_add_u32 v90, s65, v175
    v_add_u32 v174, 64, v1
    v_mul_u32_u24 v175, s62, v174
    v_lshrrev_b32 v175, 14, v175
    v_lshlrev_b32 v175, 5, v175
    v_lshl_add_u32 v175, v174, 4, v175
    v_add_u32 v91, s65, v175
    v_add_u32 v174, 128, v1
    v_mul_u32_u24 v175, s62, v174
    v_lshrrev_b32 v175, 14, v175
    v_lshlrev_b32 v175, 5, v175
    v_lshl_add_u32 v175, v174, 4, v175
    v_add_u32 v92, s65, v175
    v_add_u32 v174, 192, v1
    v_mul_u32_u24 v175, s62, v174
    v_lshrrev_b32 v175, 14, v175
    v_lshlrev_b32 v175, 5, v175
    v_lshl_add_u32 v175, v174, 4, v175
    v_add_u32 v93, s65, v175
    v_add_u32 v174, 256, v1
    v_mul_u32_u24 v175, s62, v174
    v_lshrrev_b32 v175, 14, v175
    v_lshlrev_b32 v175, 5, v175
    v_lshl_add_u32 v175, v174, 4, v175
    v_add_u32 v94, s65, v175
    v_add_u32 v174, 320, v1
    v_mul_u32_u24 v175, s62, v174
    v_lshrrev_b32 v175, 14, v175
    v_lshlrev_b32 v175, 5, v175
    v_lshl_add_u32 v175, v174, 4, v175
    v_add_u32 v95, s65, v175
    v_add_u32 v174, 384, v1
    v_mul_u32_u24 v175, s62, v174
    v_lshrrev_b32 v175, 14, v175
    v_lshlrev_b32 v175, 5, v175
    v_lshl_add_u32 v175, v174, 4, v175
    v_add_u32 v96, s65, v175
    v_add_u32 v174, 448, v1
    v_mul_u32_u24 v175, s62, v174
    v_lshrrev_b32 v175, 14, v175
    v_lshlrev_b32 v175, 5, v175
    v_lshl_add_u32 v175, v174, 4, v175
    v_add_u32 v97, s65, v175
    v_add_u32 v174, 512, v1
    v_mul_u32_u24 v175, s62, v174
    v_lshrrev_b32 v175, 14, v175
    v_lshlrev_b32 v175, 5, v175
    v_lshl_add_u32 v175, v174, 4, v175
    v_add_u32 v98, s65, v175
    v_add_u32 v174, 576, v1
    v_mul_u32_u24 v175, s62, v174
    v_lshrrev_b32 v175, 14, v175
    v_lshlrev_b32 v175, 5, v175
    v_lshl_add_u32 v175, v174, 4, v175
    v_add_u32 v99, s65, v175
    s_waitcnt vmcnt(11)
    ds_write_b128 v90, v[196:199]
    ds_write_b128 v91, v[200:203]
    ds_write_b128 v92, v[204:207]
    ds_write_b128 v93, v[208:211]
    ds_write_b128 v94, v[212:215]
    ds_write_b128 v95, v[216:219]
    s_waitcnt vmcnt(2)
    ds_write_b128 v96, v[220:223]
    ds_write_b128 v97, v[224:227]
    ds_write_b128 v98, v[228:231]
    ds_write_b128 v99, v[232:235]
    s_mov_b32 s71, 0
    s_mov_b64 s[72:73], exec
L_ho_28:
    s_waitcnt vmcnt(0)
    v_xor_b32 v5, s59, v154
    v_xor_b32 v6, s60, v155
    v_or_b32 v4, v5, v6
    v_xor_b32 v5, s59, v158
    v_xor_b32 v6, s60, v159
    v_or3_b32 v4, v4, v5, v6
    v_cmp_ne_u32 vcc, 0, v4
    s_and_b64 exec, exec, vcc
    s_cbranch_execz L_hod_29
    s_add_u32 s71, s71, 1
    s_cmp_ge_u32 s71, 100000
    s_cbranch_scc1 L_hod_29
    buffer_load_dwordx4 v[152:155], v182, s[36:39], s64 offen sc1
    buffer_load_dwordx4 v[156:159], v182, s[36:39], s64 offen offset:2048 sc1
    s_branch L_ho_28
L_hod_29:
    s_mov_b64 exec, s[72:73]
    v_add_f32 v152, v152, v156
    v_add_f32 v153, v153, v157
    s_nop 1
    v_permlane32_swap_b32 v152, v153
    s_nop 0
    v_add_f32 v152, v152, v153
    v_cvt_pk_bf16_f32 v152, v152, v152
    v_and_b32 v152, 0xffff0000, v152
    v_mul_f32 v153, 0xbfb8aa3b, v152
    v_exp_f32 v153, v153
    s_nop 0
    v_add_f32 v153, 1.0, v153
    v_rcp_f32 v153, v153
    s_nop 0
    v_mul_f32 v152, v152, v153
    v_cvt_pk_bf16_f32 v152, v152, v152
    ds_write_b16 v179, v152
    s_waitcnt lgkmcnt(0)
    s_barrier
    ds_read_b128 v[152:155], v180
    ds_read_b64_tr_b16 v[50:51], v178 offset:0
    ds_read_b64_tr_b16 v[52:53], v178 offset:20992
    ds_read_b64_tr_b16 v[54:55], v178 offset:32
    ds_read_b64_tr_b16 v[56:57], v178 offset:21024
    ds_read_b64_tr_b16 v[58:59], v178 offset:64
    ds_read_b64_tr_b16 v[60:61], v178 offset:21056
    ds_read_b64_tr_b16 v[62:63], v178 offset:96
    ds_read_b64_tr_b16 v[64:65], v178 offset:21088
    ds_read_b64_tr_b16 v[66:67], v178 offset:128
    ds_read_b64_tr_b16 v[68:69], v178 offset:21120
    ds_read_b64_tr_b16 v[70:71], v178 offset:160
    ds_read_b64_tr_b16 v[72:73], v178 offset:21152
    ds_read_b64_tr_b16 v[74:75], v178 offset:192
    ds_read_b64_tr_b16 v[76:77], v178 offset:21184
    ds_read_b64_tr_b16 v[78:79], v178 offset:224
    ds_read_b64_tr_b16 v[80:81], v178 offset:21216
    ds_read_b64_tr_b16 v[82:83], v178 offset:256
    ds_read_b64_tr_b16 v[84:85], v178 offset:21248
    ds_read_b64_tr_b16 v[86:87], v178 offset:288
    ds_read_b64_tr_b16 v[88:89], v178 offset:21280
    s_waitcnt lgkmcnt(0)
    v_mfma_f32_16x16x32_bf16 v[110:113], v[152:155], v[50:53], 0
    v_mfma_f32_16x16x32_bf16 v[114:117], v[152:155], v[54:57], 0
    v_mfma_f32_16x16x32_bf16 v[118:121], v[152:155], v[58:61], 0
    v_mfma_f32_16x16x32_bf16 v[122:125], v[152:155], v[62:65], 0
    v_mfma_f32_16x16x32_bf16 v[126:129], v[152:155], v[66:69], 0
    v_mfma_f32_16x16x32_bf16 v[130:133], v[152:155], v[70:73], 0
    v_mfma_f32_16x16x32_bf16 v[134:137], v[152:155], v[74:77], 0
    v_mfma_f32_16x16x32_bf16 v[138:141], v[152:155], v[78:81], 0
    v_mfma_f32_16x16x32_bf16 v[142:145], v[152:155], v[82:85], 0
    v_mfma_f32_16x16x32_bf16 v[146:149], v[152:155], v[86:89], 0
    s_nop 7
    v_cndmask_b32 v166, v110, v114, s[74:75]
    v_cndmask_b32 v174, v118, v122, s[74:75]
    v_cndmask_b32 v166, v166, v174, s[76:77]
    v_cndmask_b32 v167, v111, v115, s[74:75]
    v_cndmask_b32 v174, v119, v123, s[74:75]
    v_cndmask_b32 v167, v167, v174, s[76:77]
    v_cndmask_b32 v168, v126, v130, s[74:75]
    v_cndmask_b32 v174, v134, v138, s[74:75]
    v_cndmask_b32 v168, v168, v174, s[76:77]
    v_cndmask_b32 v169, v127, v131, s[74:75]
    v_cndmask_b32 v174, v135, v139, s[74:75]
    v_cndmask_b32 v169, v169, v174, s[76:77]
    v_cndmask_b32 v170, v142, v146, s[74:75]
    v_cndmask_b32 v171, v143, v147, s[74:75]
    buffer_store_dwordx2 v[166:167], v183, s[36:39], s63 offen sc1
    buffer_store_dwordx2 v[168:169], v183, s[36:39], s63 offen offset:512 sc1
    s_mov_b32 exec_hi, 0
    buffer_store_dwordx2 v[170:171], v183, s[36:39], s63 offen offset:1024 sc1
    s_mov_b64 exec, -1
    s_branch L_done
L_B_r3:
    s_cmp_eq_u32 s13, 3
    s_cbranch_scc0 L_done
    s_lshl_b32 s61, s12, 1
    s_and_b32 s62, s56, 1
    s_add_u32 s61, s61, s62
    s_lshl_b32 s62, s62, 8
    s_add_u32 s62, s62, 81920
    v_lshlrev_b32 v55, 2, v1
    v_add_u32 v55, s62, v55
    v_and_b32 v44, 7, v1
    v_lshrrev_b32 v45, 1, v3
    v_lshl_add_u32 v44, v44, 1, v45
    v_and_b32 v45, 1, v3
    v_mul_u32_u24 v45, 640, v45
    v_add_u32 v44, v44, v45
    v_lshlrev_b32 v44, 1, v44
    s_lshl_b32 s62, s61, 5
    buffer_load_ushort v46, v44, s[28:31], s62 offen
    v_and_b32 v47, 7, v1
    v_lshlrev_b32 v47, 2, v47
    v_and_b32 v48, 1, v3
    v_mul_u32_u24 v48, 1280, v48
    v_add_u32 v47, v47, v48
    buffer_load_dword v252, v47, s[52:55], s62 offen
    v_lshrrev_b32 v48, 3, v1
    v_mul_u32_u24 v48, 5120, v48
    v_and_b32 v49, 7, v1
    v_lshl_add_u32 v48, v49, 4, v48
    s_lshl_b32 s63, s61, 7
    v_lshlrev_b32 v49, 3, v1
    s_mov_b32 s4, 925696
    s_mov_b32 s5, 926208
    s_mov_b32 s71, 0
    s_mov_b64 s[72:73], exec
    buffer_load_dwordx2 v[10:11], v49, s[36:39], s4 offen sc1
    buffer_load_dwordx2 v[12:13], v49, s[36:39], s5 offen sc1
L_zf_30:
    s_waitcnt vmcnt(0)
    v_xor_b32 v5, s59, v10
    v_xor_b32 v6, s60, v11
    v_or_b32 v4, v5, v6
    v_xor_b32 v5, s59, v12
    v_xor_b32 v6, s60, v13
    v_or3_b32 v4, v4, v5, v6
    v_cmp_ne_u32 vcc, 0, v4
    s_and_b64 exec, exec, vcc
    s_cbranch_execz L_zfd_31
    s_add_u32 s71, s71, 1
    s_cmp_ge_u32 s71, 100000
    s_cbranch_scc1 L_zfd_31
    buffer_load_dwordx2 v[10:11], v49, s[36:39], s4 offen sc1
    buffer_load_dwordx2 v[12:13], v49, s[36:39], s5 offen sc1
    s_branch L_zf_30
L_zfd_31:
    s_mov_b64 exec, s[72:73]
    s_cmp_ge_u32 s56, 2
    s_cbranch_scc1 L_Z_s
    v_cmp_gt_u32 vcc, 54, v1
    s_nop 1
    v_cndmask_b32 v49, 0, v1, vcc
    v_bfe_u32 v50, v49, 5, 1
    v_lshlrev_b32 v50, 13, v50
    v_and_b32 v49, 31, v49
    v_lshl_add_u32 v49, v49, 3, v50
    s_mov_b32 s4, 332032
    s_mov_b32 s71, 0
    s_mov_b64 s[72:73], exec
    buffer_load_dwordx2 v[10:11], v49, s[36:39], s4 offen sc1
L_zs_32:
    s_waitcnt vmcnt(0)
    v_max_u32 v4, v10, v11
    v_cmp_eq_u32 vcc, -1, v4
    s_and_b64 exec, exec, vcc
    s_cbranch_execz L_zsd_33
    s_add_u32 s71, s71, 1
    s_cmp_ge_u32 s71, 100000
    s_cbranch_scc1 L_zsd_33
    buffer_load_dwordx2 v[10:11], v49, s[36:39], s4 offen sc1
    s_branch L_zs_32
L_zsd_33:
    s_mov_b64 exec, s[72:73]
    s_add_u32 s64, s63, 577536
    v_add_u32 v49, s64, v48
    v_add_u32 v50, 245760, v49
    v_cmp_gt_u32 vcc, 48, v1
    s_mov_b64 s[74:75], vcc
    s_nop 1
    v_cndmask_b32 v50, v49, v50, vcc
    s_mov_b32 s4, 0
    s_mov_b32 s5, 40960
    s_mov_b32 s6, 81920
    s_mov_b32 s7, 122880
    s_mov_b32 s8, 163840
    s_mov_b32 s9, 204800
    s_mov_b32 s71, 0
    s_mov_b64 s[72:73], exec
    buffer_load_dwordx4 v[10:13], v49, s[36:39], s4 offen sc1
    buffer_load_dwordx4 v[14:17], v49, s[36:39], s5 offen sc1
    buffer_load_dwordx4 v[18:21], v49, s[36:39], s6 offen sc1
    buffer_load_dwordx4 v[22:25], v49, s[36:39], s7 offen sc1
    buffer_load_dwordx4 v[26:29], v49, s[36:39], s8 offen sc1
    buffer_load_dwordx4 v[30:33], v49, s[36:39], s9 offen sc1
    buffer_load_dwordx4 v[34:37], v50, s[36:39], 0 offen sc1
L_fp_34:
    s_waitcnt vmcnt(0)
    v_max3_u32 v4, v10, v11, v12
    v_max3_u32 v4, v4, v13, v14
    v_max3_u32 v4, v4, v15, v16
    v_max3_u32 v4, v4, v17, v18
    v_max3_u32 v4, v4, v19, v20
    v_max3_u32 v4, v4, v21, v22
    v_max3_u32 v4, v4, v23, v24
    v_max3_u32 v4, v4, v25, v26
    v_max3_u32 v4, v4, v27, v28
    v_max3_u32 v4, v4, v29, v30
    v_max3_u32 v4, v4, v31, v32
    v_max3_u32 v4, v4, v33, v34
    v_max3_u32 v4, v4, v35, v36
    v_max_u32 v4, v4, v37
    v_cmp_eq_u32 vcc, -1, v4
    s_and_b64 exec, exec, vcc
    s_cbranch_execz L_fpd_35
    s_add_u32 s71, s71, 1
    s_cmp_ge_u32 s71, 100000
    s_cbranch_scc1 L_fpd_35
    buffer_load_dwordx4 v[10:13], v49, s[36:39], s4 offen sc1
    buffer_load_dwordx4 v[14:17], v49, s[36:39], s5 offen sc1
    buffer_load_dwordx4 v[18:21], v49, s[36:39], s6 offen sc1
    buffer_load_dwordx4 v[22:25], v49, s[36:39], s7 offen sc1
    buffer_load_dwordx4 v[26:29], v49, s[36:39], s8 offen sc1
    buffer_load_dwordx4 v[30:33], v49, s[36:39], s9 offen sc1
    buffer_load_dwordx4 v[34:37], v50, s[36:39], 0 offen sc1
    s_branch L_fp_34
L_fpd_35:
    s_mov_b64 exec, s[72:73]
    v_cndmask_b32 v34, 0, v34, s[74:75]
    v_cndmask_b32 v35, 0, v35, s[74:75]
    v_cndmask_b32 v36, 0, v36, s[74:75]
    v_cndmask_b32 v37, 0, v37, s[74:75]
    v_add_f32 v10, v10, v14
    v_add_f32 v18, v18, v22
    v_add_f32 v26, v26, v30
    v_add_f32 v11, v11, v15
    v_add_f32 v19, v19, v23
    v_add_f32 v27, v27, v31
    v_add_f32 v12, v12, v16
    v_add_f32 v20, v20, v24
    v_add_f32 v28, v28, v32
    v_add_f32 v13, v13, v17
    v_add_f32 v21, v21, v25
    v_add_f32 v29, v29, v33
    v_add_f32 v10, v10, v18
    v_add_f32 v26, v26, v34
    v_add_f32 v11, v11, v19
    v_add_f32 v27, v27, v35
    v_add_f32 v12, v12, v20
    v_add_f32 v28, v28, v36
    v_add_f32 v13, v13, v21
    v_add_f32 v29, v29, v37
    v_add_f32 v10, v10, v26
    v_add_f32 v11, v11, v27
    v_add_f32 v12, v12, v28
    v_add_f32 v13, v13, v29
    s_nop 1
    v_permlane32_swap_b32 v10, v12
    v_permlane32_swap_b32 v11, v13
    s_nop 0
    v_add_f32 v10, v10, v12
    v_add_f32 v11, v11, v13
    s_nop 1
    v_permlane16_swap_b32 v10, v11
    s_nop 0
    v_add_f32 v52, v10, v11
    s_nop 1
    v_add_f32_dpp v52, v52, v52 row_ror:8 row_mask:0xf bank_mask:0xf
    v_cvt_pk_bf16_f32 v52, v52, v52
    v_and_b32 v52, 0xffff0000, v52
    v_mul_f32 v53, 0xbfb8aa3b, v52
    v_exp_f32 v53, v53
    s_nop 0
    v_add_f32 v53, 1.0, v53
    v_rcp_f32 v53, v53
    s_nop 0
    v_mul_f32 v52, v52, v53
    v_cvt_pk_bf16_f32 v52, v52, v52
    v_and_b32 v52, 0xffff0000, v52
    ds_write_b32 v55, v52
    s_waitcnt lgkmcnt(0)
    s_barrier
    s_branch L_done
L_Z_s:
    v_lshlrev_b32 v46, 16, v46
    s_add_u32 s64, s63, 413696
    v_add_u32 v49, s64, v48
    s_mov_b32 s4, 0
    s_mov_b32 s5, 40960
    s_mov_b32 s6, 81920
    s_mov_b32 s7, 122880
    s_mov_b32 s71, 0
    s_mov_b64 s[72:73], exec
    buffer_load_dwordx4 v[10:13], v49, s[36:39], s4 offen sc1
    buffer_load_dwordx4 v[14:17], v49, s[36:39], s5 offen sc1
    buffer_load_dwordx4 v[18:21], v49, s[36:39], s6 offen sc1
    buffer_load_dwordx4 v[22:25], v49, s[36:39], s7 offen sc1
L_sp_36:
    s_waitcnt vmcnt(0)
    v_max3_u32 v4, v10, v11, v12
    v_max3_u32 v4, v4, v13, v14
    v_max3_u32 v4, v4, v15, v16
    v_max3_u32 v4, v4, v17, v18
    v_max3_u32 v4, v4, v19, v20
    v_max3_u32 v4, v4, v21, v22
    v_max3_u32 v4, v4, v23, v24
    v_max_u32 v4, v4, v25
    v_cmp_eq_u32 vcc, -1, v4
    s_and_b64 exec, exec, vcc
    s_cbranch_execz L_spd_37
    s_add_u32 s71, s71, 1
    s_cmp_ge_u32 s71, 100000
    s_cbranch_scc1 L_spd_37
    buffer_load_dwordx4 v[10:13], v49, s[36:39], s4 offen sc1
    buffer_load_dwordx4 v[14:17], v49, s[36:39], s5 offen sc1
    buffer_load_dwordx4 v[18:21], v49, s[36:39], s6 offen sc1
    buffer_load_dwordx4 v[22:25], v49, s[36:39], s7 offen sc1
    s_branch L_sp_36
L_spd_37:
    s_mov_b64 exec, s[72:73]
    s_cmp_eq_u32 s61, 0
    s_cbranch_scc0 L_ep_38
    v_mov_b32 v44, 0
    v_mov_b32 v45, s59
    s_mov_b64 exec, 1
    buffer_store_dword v45, v44, s[36:39], 0 offen offset:0
    s_mov_b64 exec, -1
L_ep_38:
    v_add_f32 v10, v10, v14
    v_add_f32 v18, v18, v22
    v_add_f32 v11, v11, v15
    v_add_f32 v19, v19, v23
    v_add_f32 v12, v12, v16
    v_add_f32 v20, v20, v24
    v_add_f32 v13, v13, v17
    v_add_f32 v21, v21, v25
    v_add_f32 v10, v10, v18
    v_add_f32 v11, v11, v19
    v_add_f32 v12, v12, v20
    v_add_f32 v13, v13, v21
    s_nop 1
    v_permlane32_swap_b32 v10, v12
    v_permlane32_swap_b32 v11, v13
    s_nop 0
    v_add_f32 v10, v10, v12
    v_add_f32 v11, v11, v13
    s_nop 1
    v_permlane16_swap_b32 v10, v11
    s_nop 0
    v_add_f32 v53, v10, v11
    s_nop 1
    v_add_f32_dpp v53, v53, v53 row_ror:8 row_mask:0xf bank_mask:0xf
    v_cvt_pk_bf16_f32 v53, v53, v53
    v_and_b32 v53, 0xffff0000, v53
    s_barrier
    ds_read_b32 v52, v55
    s_waitcnt lgkmcnt(0)
    v_mul_f32 v53, v53, v52
    v_cvt_pk_bf16_f32 v53, v53, v53
    v_and_b32 v53, 0xffff0000, v53
    v_add_f32 v53, v53, v46
    v_cvt_pk_bf16_f32 v53, v53, v53
    v_mov_b32 v54, v53
    s_nop 1
    v_permlane32_swap_b32 v53, v54
    s_nop 0
    v_and_b32 v53, 0xffff, v53
    v_lshl_or_b32 v53, v54, 16, v53
    s_mov_b32 exec_lo, 0x00ff00ff
    s_mov_b32 exec_hi, 0
    s_lshl_b32 s62, s61, 5
    buffer_store_dword v53, v47, s[52:55], s62 offen
    s_mov_b64 exec, -1
L_done:
L_exit:
    s_endpgm
.section .rodata,"a"
.p2align 6
.amdhsa_kernel recurrent_scan__compressed_kv_cla__dense_activation_silu__decode_kernel
  .amdhsa_next_free_vgpr 512
  .amdhsa_next_free_sgpr 102
  .amdhsa_accum_offset 256
  .amdhsa_group_segment_fixed_size 0
  .amdhsa_kernarg_size 96
  .amdhsa_user_sgpr_count 2
  .amdhsa_user_sgpr_kernarg_segment_ptr 1
  .amdhsa_system_sgpr_workgroup_id_x 1
.end_amdhsa_kernel
```
